```python
import torch

def _softmax(x, axis=-1):
    return torch.softmax(x, dim=axis)

def _gelu(x):
    return torch.nn.functional.gelu(x, approximate='tanh')

def _silu(x):
    return torch.nn.functional.silu(x)

def _sigmoid(x):
    return torch.sigmoid(x)

def _layernorm(x, axis=-1, eps=1e-05):
    m = x.mean(dim=axis, keepdim=True)
    v = x.var(dim=axis, keepdim=True, unbiased=False)
    return (x - m) / torch.sqrt(v + eps)

def _scatter_add(tgt, idx, src, axis=0):
    return tgt.clone().index_add_(axis, idx, src)

def _segment_sum(src, seg, n):
    out = torch.zeros((n,) + src.shape[1:], dtype=src.dtype)
    return out.index_add_(0, seg, src)

def _pad(x, pw):
    flat = tuple((v for pair in reversed(pw) for v in pair))
    return torch.nn.functional.pad(x, flat)
kernel_name = 'gather_scatter__molecular_angular_painn__graph'

def setup_inputs():

    _w = lambda a: (lambda t: t.to(torch.bfloat16) if t.is_floating_point() else t)(torch.as_tensor(a))
    N, deg, D = (10000, 16, 256)
    n_rbf = max(4, 4)
    E = N * deg
    cutoff = 5.0
    freqs = (torch.arange(1, n_rbf + 1) * torch.pi / cutoff).to(float)
    return {'sv': _w((lambda *s: torch.randn(*s, dtype=torch.bfloat16) * 0.4)(N, 4, D) * 0.3), 'pos': _w((lambda *s: torch.randn(*s, dtype=torch.bfloat16) * 3.2)(N, 3) * 1.2), 'src': _w((lambda lo, hi, *s: torch.randint(lo, hi, s))(0, N, E).to(torch.int64)), 'dst': _w((lambda lo, hi, *s: torch.randint(lo, hi, s))(0, N, E).to(torch.int64)), 'freqs': _w(freqs), 'w_phi1': _w((lambda *s: torch.randn(*s, dtype=torch.bfloat16) * 3.2)(D, D) / D ** 0.5), 'w_phi2': _w((lambda *s: torch.randn(*s, dtype=torch.bfloat16) * 3.2)(D, 3 * D) / D ** 0.5), 'w_rbf': _w((lambda *s: torch.randn(*s, dtype=torch.bfloat16) * 3.2)(n_rbf, 3 * D) / n_rbf ** 0.5)}

def reference(sv, pos, src, dst, freqs, w_phi1, w_phi2, w_rbf):
    N, _, D = sv.shape
    E = src.shape[0]
    PI, cutoff = (3.141592653589793, 5.0)
    s, v = (sv[:, 0, :].clone(), sv[:, 1:, :].clone())
    r_vec = pos[src] - pos[dst]
    d = torch.sqrt((r_vec * r_vec).sum(-1) + 1e-08)
    r_hat = r_vec / d[:, None]
    rbf = torch.sin(d[:, None] * freqs[None, :]) / d[:, None]
    fcut = 0.5 * (torch.cos(PI * d / cutoff) + 1.0)
    fcut = torch.where(d < cutoff, fcut, 0.0 * d)
    Wf = rbf @ w_rbf * fcut[:, None]
    phi = (_silu(s @ w_phi1) @ w_phi2)[src]
    m = phi * Wf
    m_s, m_vv, m_vr = (m[:, :D].clone(), m[:, D:2 * D].clone(), m[:, 2 * D:].clone())
    ds = _segment_sum(m_s, dst, N)
    dv_e = m_vv[:, None, :] * v[src] + m_vr[:, None, :] * r_hat[:, :, None]
    dv = _segment_sum(dv_e.reshape(E, 3 * D), dst, N).reshape(N, 3, D)
    return sv + torch.concatenate([ds[:, None, :], dv], axis=1)
```

```asm
; @launch kernel=painn_prep_kernel grid=(240,1,1) block=(512,1,1) lds=163840
; @launch kernel=gather_scatter__molecular_angular_painn__graph_kernel grid=(2500,1,1) block=(256,1,1) lds=0
.amdgcn_target "amdgcn-amd-amdhsa--gfx950"
.text
.globl painn_prep_kernel
.p2align 8
.type painn_prep_kernel,@function
painn_prep_kernel:
    s_cmp_ge_u32 s2, 240
    s_cbranch_scc1 K1_end
    s_and_b32 s7, s2, 7
    s_lshr_b32 s6, s2, 3
    s_mul_hi_u32 s5, s6, 0x55555556
    s_mul_i32 s3, s5, 3
    s_sub_u32 s6, s6, s3
    s_lshl_b32 s5, s5, 3
    s_add_u32 s5, s5, s7
    s_cmp_ge_u32 s5, 79
    s_cbranch_scc1 K1_end
    s_mul_i32 s2, s5, 3
    s_add_u32 s2, s2, s6
    s_load_dwordx4 s[60:63], s[0:1], 0
    s_load_dwordx4 s[64:67], s[0:1], 16
    s_load_dwordx4 s[68:71], s[0:1], 32
    s_load_dwordx4 s[72:75], s[0:1], 48
    s_load_dwordx4 s[76:79], s[0:1], 72
    v_and_b32 v1, 63, v0
    v_lshrrev_b32 v2, 6, v0
    s_nop 0
    v_readfirstlane_b32 s4, v2
    s_mul_hi_u32 s5, s2, 0x55555556
    s_mul_i32 s6, s5, 3
    s_sub_u32 s6, s2, s6
    s_waitcnt lgkmcnt(0)
    s_load_dwordx2 s[80:81], s[68:69], 0
    s_mov_b32 s8, s60
    s_and_b32 s9, s61, 0xffff
    s_mov_b32 s10, 20480000
    s_mov_b32 s11, 0x20000
    s_mov_b32 s24, s62
    s_and_b32 s25, s63, 0xffff
    s_mov_b32 s26, 60000
    s_mov_b32 s27, 0x20000
    s_mov_b32 s36, s64
    s_and_b32 s37, s65, 0xffff
    s_mov_b32 s38, 640000
    s_mov_b32 s39, 0x20000
    s_mov_b32 s40, s66
    s_and_b32 s41, s67, 0xffff
    s_mov_b32 s42, 640000
    s_mov_b32 s43, 0x20000
    s_mov_b32 s12, s70
    s_and_b32 s13, s71, 0xffff
    s_mov_b32 s14, 131072
    s_mov_b32 s15, 0x20000
    s_mov_b32 s16, s72
    s_and_b32 s17, s73, 0xffff
    s_mov_b32 s18, 393216
    s_mov_b32 s19, 0x20000
    s_mov_b32 s52, s74
    s_and_b32 s53, s75, 0xffff
    s_mov_b32 s54, 6144
    s_mov_b32 s55, 0x20000
    s_mov_b32 s48, s76
    s_and_b32 s49, s77, 0xffff
    s_mov_b32 s50, 256
    s_mov_b32 s51, 0x20000
    s_mov_b32 s20, s78
    s_and_b32 s21, s79, 0xffff
    s_mov_b32 s22, 15360000
    s_mov_b32 s23, 0x20000
    s_add_u32 s28, s78, 16777216
    s_addc_u32 s29, s79, 0
    s_and_b32 s29, s29, 0xffff
    s_mov_b32 s30, 40064
    s_mov_b32 s31, 0x20000
    s_add_u32 s56, s78, 16842752
    s_addc_u32 s57, s79, 0
    s_and_b32 s57, s57, 0xffff
    s_mov_b32 s58, 6144
    s_mov_b32 s59, 0x20000
    s_add_u32 s32, s78, 17825792
    s_addc_u32 s33, s79, 0
    s_and_b32 s33, s33, 0xffff
    s_mov_b32 s34, 10240000
    s_mov_b32 s35, 0x20000
    s_add_u32 s44, s78, 33554432
    s_addc_u32 s45, s79, 0
    s_and_b32 s45, s45, 0xffff
    s_mov_b32 s46, 5120000
    s_mov_b32 s47, 0x20000
    s_cmp_ge_u32 s2, 16
    s_cbranch_scc1 K1_nozero
    s_cmp_lg_u32 s4, 0
    s_cbranch_scc1 K1_nozero
    v_mov_b32 v8, 0
    v_mov_b32 v9, 0
    v_mov_b32 v10, 0
    v_mov_b32 v11, 0
    s_mul_i32 s7, s2, 2560
    v_lshl_add_u32 v2, v1, 4, s7
    buffer_store_dwordx4 v[8:11], v2, s[28:31], 0 offen sc0 sc1
    buffer_store_dwordx4 v[8:11], v2, s[28:31], 0 offen offset:1024 sc0 sc1
    v_cmp_gt_u32 vcc, 32, v1
    s_and_saveexec_b64 s[82:83], vcc
    buffer_store_dwordx4 v[8:11], v2, s[28:31], 0 offen offset:2048 sc0 sc1
    s_mov_b64 exec, s[82:83]
K1_nozero:
    s_cmp_lg_u32 s2, 16
    s_cbranch_scc1 K1_nopack
    s_cmp_ge_u32 s4, 3
    s_cbranch_scc1 K1_nopack
    s_lshl_b32 s7, s4, 9
    v_lshl_add_u32 v2, v1, 3, s7
    s_movk_i32 s82, 3072
    buffer_load_dwordx2 v[48:49], v2, s[52:55], 0 offen offset:0
    buffer_load_dwordx2 v[50:51], v2, s[52:55], 0 offen offset:1536
    buffer_load_dwordx2 v[60:61], v2, s[52:55], s82 offen offset:0
    buffer_load_dwordx2 v[62:63], v2, s[52:55], s82 offen offset:1536
K1_nopack:
    s_and_b32 s56, s4, 3
    s_lshr_b32 s57, s4, 2
    s_lshr_b32 s58, s2, 3
    s_and_b32 s58, s58, 3
    s_add_u32 s64, s58, 0
    s_and_b32 s64, s64, 3
    s_lshl_b32 s64, s64, 7
    s_add_u32 s65, s58, 1
    s_and_b32 s65, s65, 3
    s_lshl_b32 s65, s65, 7
    s_add_u32 s66, s58, 2
    s_and_b32 s66, s66, 3
    s_lshl_b32 s66, s66, 7
    s_add_u32 s67, s58, 3
    s_and_b32 s67, s67, 3
    s_lshl_b32 s67, s67, 7
    v_lshrrev_b32 v2, 4, v1
    v_and_b32 v2, 1, v2
    v_mul_u32_u24 v2, 6, v2
    v_and_b32 v13, 7, v1
    v_xor_b32 v2, v2, v13
    v_lshlrev_b32 v2, 4, v2
    v_lshrrev_b32 v13, 3, v1
    v_lshl_add_u32 v7, v13, 9, v2
    v_mul_u32_u24 v13, 1536, v13
    v_add_u32 v8, v13, v2
    s_lshl_b32 s84, s4, 12
    s_lshl_b32 s85, s4, 14
    s_mul_i32 s86, s4, 49152
    s_lshl_b32 s82, s6, 9
    s_add_u32 s86, s86, s82
    s_add_u32 m0, s84, 0
    s_add_u32 s87, s85, 0
    s_add_u32 s87, s87, s64
    buffer_load_dwordx4 v7, s[12:15], s87 offen lds
    s_add_u32 m0, s84, 1024
    s_add_u32 s87, s85, 4096
    s_add_u32 s87, s87, s64
    buffer_load_dwordx4 v7, s[12:15], s87 offen lds
    s_add_u32 m0, s84, 2048
    s_add_u32 s87, s85, 8192
    s_add_u32 s87, s87, s64
    buffer_load_dwordx4 v7, s[12:15], s87 offen lds
    s_add_u32 m0, s84, 3072
    s_add_u32 s87, s85, 12288
    s_add_u32 s87, s87, s64
    buffer_load_dwordx4 v7, s[12:15], s87 offen lds
    s_lshl_b32 s7, s5, 7
    s_lshl_b32 s82, s56, 5
    s_add_u32 s7, s7, s82
    v_lshrrev_b32 v3, 5, v1
    v_and_b32 v4, 31, v1
    s_lshl_b32 s82, s57, 4
    v_add_u32 v5, s82, v3
    s_lshl_b32 s83, s56, 14
    s_add_u32 s83, s83, 65536
    s_lshl_b32 s82, s57, 13
    s_add_u32 s59, s83, s82
    v_add_u32 v13, 0, v5
    v_and_b32 v2, 15, v13
    v_xor_b32 v2, v2, v4
    v_lshlrev_b32 v2, 4, v2
    v_add_u32 v13, s7, v13
    s_add_u32 m0, s59, 0
    v_lshl_add_u32 v2, v13, 11, v2
    buffer_load_dwordx4 v2, s[8:11], 0 offen lds
    v_add_u32 v13, 2, v5
    v_and_b32 v2, 15, v13
    v_xor_b32 v2, v2, v4
    v_lshlrev_b32 v2, 4, v2
    v_add_u32 v13, s7, v13
    s_add_u32 m0, s59, 1024
    v_lshl_add_u32 v2, v13, 11, v2
    buffer_load_dwordx4 v2, s[8:11], 0 offen lds
    v_add_u32 v13, 4, v5
    v_and_b32 v2, 15, v13
    v_xor_b32 v2, v2, v4
    v_lshlrev_b32 v2, 4, v2
    v_add_u32 v13, s7, v13
    s_add_u32 m0, s59, 2048
    v_lshl_add_u32 v2, v13, 11, v2
    buffer_load_dwordx4 v2, s[8:11], 0 offen lds
    v_add_u32 v13, 6, v5
    v_and_b32 v2, 15, v13
    v_xor_b32 v2, v2, v4
    v_lshlrev_b32 v2, 4, v2
    v_add_u32 v13, s7, v13
    s_add_u32 m0, s59, 3072
    v_lshl_add_u32 v2, v13, 11, v2
    buffer_load_dwordx4 v2, s[8:11], 0 offen lds
    v_add_u32 v13, 8, v5
    v_and_b32 v2, 15, v13
    v_xor_b32 v2, v2, v4
    v_lshlrev_b32 v2, 4, v2
    v_add_u32 v13, s7, v13
    s_add_u32 m0, s59, 4096
    v_lshl_add_u32 v2, v13, 11, v2
    buffer_load_dwordx4 v2, s[8:11], 0 offen lds
    v_add_u32 v13, 10, v5
    v_and_b32 v2, 15, v13
    v_xor_b32 v2, v2, v4
    v_lshlrev_b32 v2, 4, v2
    v_add_u32 v13, s7, v13
    s_add_u32 m0, s59, 5120
    v_lshl_add_u32 v2, v13, 11, v2
    buffer_load_dwordx4 v2, s[8:11], 0 offen lds
    v_add_u32 v13, 12, v5
    v_and_b32 v2, 15, v13
    v_xor_b32 v2, v2, v4
    v_lshlrev_b32 v2, 4, v2
    v_add_u32 v13, s7, v13
    s_add_u32 m0, s59, 6144
    v_lshl_add_u32 v2, v13, 11, v2
    buffer_load_dwordx4 v2, s[8:11], 0 offen lds
    v_add_u32 v13, 14, v5
    v_and_b32 v2, 15, v13
    v_xor_b32 v2, v2, v4
    v_lshlrev_b32 v2, 4, v2
    v_add_u32 v13, s7, v13
    s_add_u32 m0, s59, 7168
    v_lshl_add_u32 v2, v13, 11, v2
    buffer_load_dwordx4 v2, s[8:11], 0 offen lds
    s_add_u32 m0, s84, 32768
    s_add_u32 s87, s85, 0
    s_add_u32 s87, s87, s65
    buffer_load_dwordx4 v7, s[12:15], s87 offen lds
    s_add_u32 m0, s84, 33792
    s_add_u32 s87, s85, 4096
    s_add_u32 s87, s87, s65
    buffer_load_dwordx4 v7, s[12:15], s87 offen lds
    s_add_u32 m0, s84, 34816
    s_add_u32 s87, s85, 8192
    s_add_u32 s87, s87, s65
    buffer_load_dwordx4 v7, s[12:15], s87 offen lds
    s_add_u32 m0, s84, 35840
    s_add_u32 s87, s85, 12288
    s_add_u32 s87, s87, s65
    buffer_load_dwordx4 v7, s[12:15], s87 offen lds
    v_lshrrev_b32 v2, 2, v1
    v_add_u32 v2, s7, v2
    s_mov_b32 s82, 1536
    v_mul_lo_u32 v6, v2, s82
    v_and_b32 v2, 3, v1
    v_lshl_add_u32 v6, v2, 4, v6
    s_lshl_b32 s82, s6, 9
    s_lshl_b32 s59, s57, 6
    s_add_u32 s82, s82, s59
    v_add_u32 v6, s82, v6
    s_lshl_b32 s82, s4, 11
    s_add_u32 s82, s82, 131072
    v_lshrrev_b32 v2, 1, v4
    v_and_b32 v2, 3, v2
    v_lshl_add_u32 v13, v3, 1, 0
    v_xor_b32 v13, v13, v2
    v_lshlrev_b32 v13, 4, v13
    v_lshl_add_u32 v13, v4, 6, v13
    v_add_u32 v32, s82, v13
    v_lshl_add_u32 v13, v3, 1, 1
    v_xor_b32 v13, v13, v2
    v_lshlrev_b32 v13, 4, v13
    v_lshl_add_u32 v13, v4, 6, v13
    v_add_u32 v33, s82, v13
    v_lshrrev_b32 v2, 3, v1
    v_and_b32 v2, 3, v2
    v_and_b32 v13, 3, v1
    v_xor_b32 v13, v13, v2
    v_lshlrev_b32 v13, 4, v13
    v_lshrrev_b32 v2, 2, v1
    v_lshl_add_u32 v13, v2, 6, v13
    v_add_u32 v34, s82, v13
    v_lshlrev_b32 v2, 4, v1
    s_lshl_b32 s82, s4, 12
    s_add_u32 s82, s82, 131072
    v_add_u32 v36, s82, v2
    s_xor_b32 s82, s4, 4
    s_lshl_b32 s82, s82, 12
    s_add_u32 s82, s82, 131072
    v_add_u32 v37, s82, v2
    v_and_b32 v2, 15, v4
    v_xor_b32 v19, v2, v3
    v_lshlrev_b32 v35, 9, v4
    v_add_u32 v35, s83, v35
    v_lshrrev_b32 v16, 2, v1
    v_and_b32 v16, 3, v16
    v_and_b32 v4, 3, v1
    v_lshrrev_b32 v13, 4, v1
    v_and_b32 v13, 1, v13
    v_lshrrev_b32 v14, 1, v16
    v_mul_u32_u24 v14, 6, v14
    v_lshlrev_b32 v15, 7, v16
    s_lshl_b32 s82, s57, 2
    v_lshl_add_u32 v16, v13, 2, v4
    v_lshrrev_b32 v17, 1, v16
    v_add_u32 v17, s82, v17
    v_xor_b32 v17, v17, v14
    v_and_b32 v16, 1, v16
    v_lshlrev_b32 v16, 3, v16
    v_lshl_add_u32 v16, v17, 4, v16
    v_add_u32 v16, v16, v15
    v_lshl_add_u32 v9, v3, 10, v16
    v_and_b32 v16, 1, v4
    v_lshl_add_u32 v16, v16, 1, v13
    v_add_u32 v16, s82, v16
    v_xor_b32 v16, v16, v14
    v_lshrrev_b32 v17, 1, v4
    v_lshlrev_b32 v17, 3, v17
    v_lshl_add_u32 v16, v16, 4, v17
    v_add_u32 v16, v16, v15
    v_lshl_add_u32 v10, v3, 9, v16
    s_lshl_b32 s82, s57, 12
    s_sub_u32 s59, 4096, s82
    s_lshl_b32 s68, s64, 6
    s_add_u32 s68, s68, s82
    v_add_u32 v52, s68, v10
    s_lshl_b32 s68, s64, 6
    s_add_u32 s68, s68, s59
    v_add_u32 v53, s68, v10
    s_lshl_b32 s68, s65, 6
    s_add_u32 s68, s68, s82
    v_add_u32 v54, s68, v10
    s_lshl_b32 s68, s65, 6
    s_add_u32 s68, s68, s59
    v_add_u32 v55, s68, v10
    s_lshl_b32 s68, s66, 6
    s_add_u32 s68, s68, s82
    v_add_u32 v56, s68, v10
    s_lshl_b32 s68, s66, 6
    s_add_u32 s68, s68, s59
    v_add_u32 v57, s68, v10
    s_lshl_b32 s68, s67, 6
    s_add_u32 s68, s68, s82
    v_add_u32 v58, s68, v10
    s_lshl_b32 s68, s67, 6
    s_add_u32 s68, s68, s59
    v_add_u32 v59, s68, v10
    v_add_u32 v20, 0x10000, v9
    s_waitcnt vmcnt(4)
    s_cmp_ge_u32 s2, 16
    s_cbranch_scc1 K1_nosig
    s_cmp_lg_u32 s4, 0
    s_cbranch_scc1 K1_nosig
    s_waitcnt vmcnt(0)
    v_cmp_eq_u32 vcc, 0, v1
    s_and_saveexec_b64 s[82:83], vcc
    v_mov_b32 v2, 0
    v_mov_b32 v13, 1
    buffer_atomic_add v13, v2, s[48:51], 0 offen sc1
    s_mov_b64 exec, s[82:83]
K1_nosig:
    s_barrier
    v_xor_b32 v13, 0, v19
    v_lshl_add_u32 v13, v13, 4, v35
    ds_read_b128 v[64:67], v13
    v_xor_b32 v13, 2, v19
    v_lshl_add_u32 v13, v13, 4, v35
    ds_read_b128 v[68:71], v13
    v_xor_b32 v13, 4, v19
    v_lshl_add_u32 v13, v13, 4, v35
    ds_read_b128 v[72:75], v13
    v_xor_b32 v13, 6, v19
    v_lshl_add_u32 v13, v13, 4, v35
    ds_read_b128 v[76:79], v13
    v_xor_b32 v13, 8, v19
    v_lshl_add_u32 v13, v13, 4, v35
    ds_read_b128 v[80:83], v13
    v_xor_b32 v13, 10, v19
    v_lshl_add_u32 v13, v13, 4, v35
    ds_read_b128 v[84:87], v13
    v_xor_b32 v13, 12, v19
    v_lshl_add_u32 v13, v13, 4, v35
    ds_read_b128 v[88:91], v13
    v_xor_b32 v13, 14, v19
    v_lshl_add_u32 v13, v13, 4, v35
    ds_read_b128 v[92:95], v13
    v_xor_b32 v13, 16, v19
    v_lshl_add_u32 v13, v13, 4, v35
    ds_read_b128 v[96:99], v13
    v_xor_b32 v13, 18, v19
    v_lshl_add_u32 v13, v13, 4, v35
    ds_read_b128 v[100:103], v13
    v_xor_b32 v13, 20, v19
    v_lshl_add_u32 v13, v13, 4, v35
    ds_read_b128 v[104:107], v13
    v_xor_b32 v13, 22, v19
    v_lshl_add_u32 v13, v13, 4, v35
    ds_read_b128 v[108:111], v13
    v_xor_b32 v13, 24, v19
    v_lshl_add_u32 v13, v13, 4, v35
    ds_read_b128 v[112:115], v13
    v_xor_b32 v13, 26, v19
    v_lshl_add_u32 v13, v13, 4, v35
    ds_read_b128 v[116:119], v13
    v_xor_b32 v13, 28, v19
    v_lshl_add_u32 v13, v13, 4, v35
    ds_read_b128 v[120:123], v13
    v_xor_b32 v13, 30, v19
    v_lshl_add_u32 v13, v13, 4, v35
    ds_read_b128 v[124:127], v13
    v_lshlrev_b32 v2, 2, v0
    s_lshl_b32 s59, s2, 11
    s_add_u32 s82, s59, 0
    v_add_u32 v30, s82, v2
    buffer_load_dword v26, v30, s[36:39], 0 offen
    buffer_load_dword v28, v30, s[40:43], 0 offen
    s_add_u32 s82, s59, 485376
    v_add_u32 v31, s82, v2
    buffer_load_dword v27, v31, s[36:39], 0 offen
    buffer_load_dword v29, v31, s[40:43], 0 offen
    s_waitcnt lgkmcnt(0)
    s_lshl_b32 s88, s80, 16
    s_and_b32 s89, s80, 0xffff0000
    s_lshl_b32 s90, s81, 16
    s_and_b32 s91, s81, 0xffff0000
    s_mov_b32 s92, 0x3e22f983
    s_mov_b32 s93, 0x40490fdb
    s_mov_b32 s94, 0x3e4ccccd
    s_mov_b32 s95, 0x40a00000
    s_mov_b32 s96, 0x322bcc77
    s_mov_b32 s97, 0xbfb8aa3b
    v_mov_b32 v18, 0x7ffffff0
    v_mov_b32 v22, 1.0
    v_mov_b32 v23, 1.0
    s_add_u32 s69, s64, 0
    s_add_u32 s70, s64, 24576
    s_add_u32 s71, s65, 0
    s_add_u32 s72, s65, 24576
    s_add_u32 s73, s66, 0
    s_add_u32 s74, s66, 24576
    s_add_u32 s75, s67, 0
    s_add_u32 s76, s67, 24576
    s_waitcnt vmcnt(16)
    s_barrier
    ds_read_b64_tr_b16 v[224:225], v9 offset:0
    ds_read_b64_tr_b16 v[226:227], v9 offset:512
    ds_read_b64_tr_b16 v[228:229], v9 offset:2048
    ds_read_b64_tr_b16 v[230:231], v9 offset:2560
    ds_read_b64_tr_b16 v[232:233], v9 offset:4096
    ds_read_b64_tr_b16 v[234:235], v9 offset:4608
    s_waitcnt lgkmcnt(4)
    v_mfma_f32_32x32x16_bf16 v[192:207], v[224:227], v[64:67], 0
    ds_read_b64_tr_b16 v[236:237], v9 offset:6144
    ds_read_b64_tr_b16 v[238:239], v9 offset:6656
    s_waitcnt lgkmcnt(4)
    v_mfma_f32_32x32x16_bf16 v[192:207], v[228:231], v[68:71], v[192:207]
    ds_read_b64_tr_b16 v[224:225], v9 offset:8192
    ds_read_b64_tr_b16 v[226:227], v9 offset:8704
    s_waitcnt lgkmcnt(4)
    v_mfma_f32_32x32x16_bf16 v[192:207], v[232:235], v[72:75], v[192:207]
    ds_read_b64_tr_b16 v[228:229], v9 offset:10240
    ds_read_b64_tr_b16 v[230:231], v9 offset:10752
    s_add_u32 m0, s84, 65536
    s_add_u32 s87, s85, 0
    s_add_u32 s87, s87, s66
    buffer_load_dwordx4 v7, s[12:15], s87 offen lds
    s_waitcnt lgkmcnt(4)
    v_mfma_f32_32x32x16_bf16 v[192:207], v[236:239], v[76:79], v[192:207]
    ds_read_b64_tr_b16 v[232:233], v9 offset:12288
    ds_read_b64_tr_b16 v[234:235], v9 offset:12800
    s_add_u32 m0, s84, 66560
    s_add_u32 s87, s85, 4096
    s_add_u32 s87, s87, s66
    buffer_load_dwordx4 v7, s[12:15], s87 offen lds
    s_waitcnt lgkmcnt(4)
    v_mfma_f32_32x32x16_bf16 v[192:207], v[224:227], v[80:83], v[192:207]
    ds_read_b64_tr_b16 v[236:237], v9 offset:14336
    ds_read_b64_tr_b16 v[238:239], v9 offset:14848
    s_add_u32 m0, s84, 67584
    s_add_u32 s87, s85, 8192
    s_add_u32 s87, s87, s66
    buffer_load_dwordx4 v7, s[12:15], s87 offen lds
    s_waitcnt lgkmcnt(4)
    v_mfma_f32_32x32x16_bf16 v[192:207], v[228:231], v[84:87], v[192:207]
    ds_read_b64_tr_b16 v[224:225], v9 offset:16384
    ds_read_b64_tr_b16 v[226:227], v9 offset:16896
    s_add_u32 m0, s84, 68608
    s_add_u32 s87, s85, 12288
    s_add_u32 s87, s87, s66
    buffer_load_dwordx4 v7, s[12:15], s87 offen lds
    s_waitcnt lgkmcnt(4)
    v_mfma_f32_32x32x16_bf16 v[192:207], v[232:235], v[88:91], v[192:207]
    ds_read_b64_tr_b16 v[228:229], v9 offset:18432
    ds_read_b64_tr_b16 v[230:231], v9 offset:18944
    s_add_u32 m0, s84, 98304
    s_add_u32 s87, s85, 0
    s_add_u32 s87, s87, s67
    buffer_load_dwordx4 v7, s[12:15], s87 offen lds
    s_waitcnt lgkmcnt(4)
    v_mfma_f32_32x32x16_bf16 v[192:207], v[236:239], v[92:95], v[192:207]
    ds_read_b64_tr_b16 v[232:233], v9 offset:20480
    ds_read_b64_tr_b16 v[234:235], v9 offset:20992
    s_add_u32 m0, s84, 99328
    s_add_u32 s87, s85, 4096
    s_add_u32 s87, s87, s67
    buffer_load_dwordx4 v7, s[12:15], s87 offen lds
    s_waitcnt lgkmcnt(4)
    v_mfma_f32_32x32x16_bf16 v[192:207], v[224:227], v[96:99], v[192:207]
    ds_read_b64_tr_b16 v[236:237], v9 offset:22528
    ds_read_b64_tr_b16 v[238:239], v9 offset:23040
    s_add_u32 m0, s84, 100352
    s_add_u32 s87, s85, 8192
    s_add_u32 s87, s87, s67
    buffer_load_dwordx4 v7, s[12:15], s87 offen lds
    s_waitcnt lgkmcnt(4)
    v_mfma_f32_32x32x16_bf16 v[192:207], v[228:231], v[100:103], v[192:207]
    ds_read_b64_tr_b16 v[224:225], v9 offset:24576
    ds_read_b64_tr_b16 v[226:227], v9 offset:25088
    s_add_u32 m0, s84, 101376
    s_add_u32 s87, s85, 12288
    s_add_u32 s87, s87, s67
    buffer_load_dwordx4 v7, s[12:15], s87 offen lds
    s_waitcnt lgkmcnt(4)
    v_mfma_f32_32x32x16_bf16 v[192:207], v[232:235], v[104:107], v[192:207]
    ds_read_b64_tr_b16 v[228:229], v9 offset:26624
    ds_read_b64_tr_b16 v[230:231], v9 offset:27136
    s_waitcnt lgkmcnt(4)
    v_mfma_f32_32x32x16_bf16 v[192:207], v[236:239], v[108:111], v[192:207]
    ds_read_b64_tr_b16 v[232:233], v9 offset:28672
    ds_read_b64_tr_b16 v[234:235], v9 offset:29184
    s_waitcnt lgkmcnt(4)
    v_mfma_f32_32x32x16_bf16 v[192:207], v[224:227], v[112:115], v[192:207]
    ds_read_b64_tr_b16 v[236:237], v9 offset:30720
    ds_read_b64_tr_b16 v[238:239], v9 offset:31232
    s_waitcnt lgkmcnt(4)
    v_mfma_f32_32x32x16_bf16 v[192:207], v[228:231], v[116:119], v[192:207]
    s_waitcnt lgkmcnt(2)
    v_mfma_f32_32x32x16_bf16 v[192:207], v[232:235], v[120:123], v[192:207]
    s_waitcnt lgkmcnt(0)
    v_mfma_f32_32x32x16_bf16 v[192:207], v[236:239], v[124:127], v[192:207]
    s_waitcnt vmcnt(12)
    s_barrier
    ds_read_b64_tr_b16 v[224:225], v9 offset:32768
    ds_read_b64_tr_b16 v[226:227], v9 offset:33280
    ds_read_b64_tr_b16 v[228:229], v9 offset:34816
    ds_read_b64_tr_b16 v[230:231], v9 offset:35328
    ds_read_b64_tr_b16 v[232:233], v9 offset:36864
    ds_read_b64_tr_b16 v[234:235], v9 offset:37376
    s_waitcnt lgkmcnt(4)
    v_mfma_f32_32x32x16_bf16 v[208:223], v[224:227], v[64:67], 0
    ds_read_b64_tr_b16 v[236:237], v9 offset:38912
    ds_read_b64_tr_b16 v[238:239], v9 offset:39424
    s_waitcnt lgkmcnt(4)
    v_mfma_f32_32x32x16_bf16 v[208:223], v[228:231], v[68:71], v[208:223]
    ds_read_b64_tr_b16 v[224:225], v9 offset:40960
    ds_read_b64_tr_b16 v[226:227], v9 offset:41472
    s_waitcnt lgkmcnt(4)
    v_mfma_f32_32x32x16_bf16 v[208:223], v[232:235], v[72:75], v[208:223]
    ds_read_b64_tr_b16 v[228:229], v9 offset:43008
    ds_read_b64_tr_b16 v[230:231], v9 offset:43520
    v_mul_f32 v240, s97, v192
    v_mul_f32 v241, s97, v193
    v_exp_f32 v240, v240
    v_exp_f32 v241, v241
    v_add_f32 v240, 1.0, v240
    v_add_f32 v241, 1.0, v241
    v_rcp_f32 v240, v240
    s_add_u32 m0, s84, 0
    s_add_u32 s87, s86, 0
    s_add_u32 s87, s87, s64
    buffer_load_dwordx4 v8, s[16:19], s87 offen lds
    s_waitcnt lgkmcnt(4)
    v_mfma_f32_32x32x16_bf16 v[208:223], v[236:239], v[76:79], v[208:223]
    ds_read_b64_tr_b16 v[232:233], v9 offset:45056
    ds_read_b64_tr_b16 v[234:235], v9 offset:45568
    v_rcp_f32 v241, v241
    v_mul_f32 v240, v192, v240
    v_mul_f32 v241, v193, v241
    v_cvt_pk_bf16_f32 v128, v240, v241
    v_mul_f32 v242, s97, v194
    v_mul_f32 v243, s97, v195
    v_exp_f32 v242, v242
    s_add_u32 m0, s84, 1024
    s_add_u32 s87, s86, 12288
    s_add_u32 s87, s87, s64
    buffer_load_dwordx4 v8, s[16:19], s87 offen lds
    s_waitcnt lgkmcnt(4)
    v_mfma_f32_32x32x16_bf16 v[208:223], v[224:227], v[80:83], v[208:223]
    ds_read_b64_tr_b16 v[236:237], v9 offset:47104
    ds_read_b64_tr_b16 v[238:239], v9 offset:47616
    v_exp_f32 v243, v243
    v_add_f32 v242, 1.0, v242
    v_add_f32 v243, 1.0, v243
    v_rcp_f32 v242, v242
    v_rcp_f32 v243, v243
    v_mul_f32 v242, v194, v242
    v_mul_f32 v243, v195, v243
    s_add_u32 m0, s84, 2048
    s_add_u32 s87, s86, 24576
    s_add_u32 s87, s87, s64
    buffer_load_dwordx4 v8, s[16:19], s87 offen lds
    s_waitcnt lgkmcnt(4)
    v_mfma_f32_32x32x16_bf16 v[208:223], v[228:231], v[84:87], v[208:223]
    ds_read_b64_tr_b16 v[224:225], v9 offset:49152
    ds_read_b64_tr_b16 v[226:227], v9 offset:49664
    v_cvt_pk_bf16_f32 v129, v242, v243
    v_mul_f32 v240, s97, v196
    v_mul_f32 v241, s97, v197
    v_exp_f32 v240, v240
    v_exp_f32 v241, v241
    v_add_f32 v240, 1.0, v240
    v_add_f32 v241, 1.0, v241
    s_add_u32 m0, s84, 3072
    s_add_u32 s87, s86, 36864
    s_add_u32 s87, s87, s64
    buffer_load_dwordx4 v8, s[16:19], s87 offen lds
    s_waitcnt lgkmcnt(4)
    v_mfma_f32_32x32x16_bf16 v[208:223], v[232:235], v[88:91], v[208:223]
    ds_read_b64_tr_b16 v[228:229], v9 offset:51200
    ds_read_b64_tr_b16 v[230:231], v9 offset:51712
    v_rcp_f32 v240, v240
    v_rcp_f32 v241, v241
    v_mul_f32 v240, v196, v240
    v_mul_f32 v241, v197, v241
    v_cvt_pk_bf16_f32 v130, v240, v241
    v_mul_f32 v242, s97, v198
    v_mul_f32 v243, s97, v199
    s_waitcnt vmcnt(12)
    s_waitcnt lgkmcnt(4)
    v_mfma_f32_32x32x16_bf16 v[208:223], v[236:239], v[92:95], v[208:223]
    ds_read_b64_tr_b16 v[232:233], v9 offset:53248
    ds_read_b64_tr_b16 v[234:235], v9 offset:53760
    v_exp_f32 v242, v242
    v_exp_f32 v243, v243
    v_add_f32 v242, 1.0, v242
    v_add_f32 v243, 1.0, v243
    v_rcp_f32 v242, v242
    v_rcp_f32 v243, v243
    v_mul_f32 v242, v198, v242
    v_mul_u32_u24 v13, 6, v26
    v_and_b32 v13, -4, v13
    buffer_load_dwordx2 v[40:41], v13, s[24:27], 0 offen
    s_waitcnt lgkmcnt(4)
    v_mfma_f32_32x32x16_bf16 v[208:223], v[224:227], v[96:99], v[208:223]
    ds_read_b64_tr_b16 v[236:237], v9 offset:55296
    ds_read_b64_tr_b16 v[238:239], v9 offset:55808
    v_mul_f32 v243, v199, v243
    v_cvt_pk_bf16_f32 v131, v242, v243
    v_mul_f32 v240, s97, v200
    v_mul_f32 v241, s97, v201
    v_exp_f32 v240, v240
    v_exp_f32 v241, v241
    v_add_f32 v240, 1.0, v240
    v_mul_u32_u24 v13, 6, v28
    v_and_b32 v13, -4, v13
    buffer_load_dwordx2 v[44:45], v13, s[24:27], 0 offen
    s_waitcnt lgkmcnt(4)
    v_mfma_f32_32x32x16_bf16 v[208:223], v[228:231], v[100:103], v[208:223]
    ds_read_b64_tr_b16 v[224:225], v9 offset:57344
    ds_read_b64_tr_b16 v[226:227], v9 offset:57856
    v_add_f32 v241, 1.0, v241
    v_rcp_f32 v240, v240
    v_rcp_f32 v241, v241
    v_mul_f32 v240, v200, v240
    v_mul_f32 v241, v201, v241
    v_cvt_pk_bf16_f32 v132, v240, v241
    v_mul_f32 v242, s97, v202
    v_mul_u32_u24 v13, 6, v27
    v_and_b32 v13, -4, v13
    buffer_load_dwordx2 v[42:43], v13, s[24:27], 0 offen
    s_waitcnt lgkmcnt(4)
    v_mfma_f32_32x32x16_bf16 v[208:223], v[232:235], v[104:107], v[208:223]
    ds_read_b64_tr_b16 v[228:229], v9 offset:59392
    ds_read_b64_tr_b16 v[230:231], v9 offset:59904
    v_mul_f32 v243, s97, v203
    v_exp_f32 v242, v242
    v_exp_f32 v243, v243
    v_add_f32 v242, 1.0, v242
    v_add_f32 v243, 1.0, v243
    v_rcp_f32 v242, v242
    v_rcp_f32 v243, v243
    v_mul_u32_u24 v13, 6, v29
    v_and_b32 v13, -4, v13
    buffer_load_dwordx2 v[46:47], v13, s[24:27], 0 offen
    s_waitcnt lgkmcnt(4)
    v_mfma_f32_32x32x16_bf16 v[208:223], v[236:239], v[108:111], v[208:223]
    ds_read_b64_tr_b16 v[232:233], v9 offset:61440
    ds_read_b64_tr_b16 v[234:235], v9 offset:61952
    v_mul_f32 v242, v202, v242
    v_mul_f32 v243, v203, v243
    v_cvt_pk_bf16_f32 v133, v242, v243
    v_mul_f32 v240, s97, v204
    v_mul_f32 v241, s97, v205
    v_exp_f32 v240, v240
    v_exp_f32 v241, v241
    s_waitcnt lgkmcnt(4)
    v_mfma_f32_32x32x16_bf16 v[208:223], v[224:227], v[112:115], v[208:223]
    ds_read_b64_tr_b16 v[236:237], v9 offset:63488
    ds_read_b64_tr_b16 v[238:239], v9 offset:64000
    v_add_f32 v240, 1.0, v240
    v_add_f32 v241, 1.0, v241
    v_rcp_f32 v240, v240
    v_rcp_f32 v241, v241
    v_mul_f32 v240, v204, v240
    v_mul_f32 v241, v205, v241
    v_cvt_pk_bf16_f32 v134, v240, v241
    s_waitcnt lgkmcnt(4)
    v_mfma_f32_32x32x16_bf16 v[208:223], v[228:231], v[116:119], v[208:223]
    v_mul_f32 v242, s97, v206
    v_mul_f32 v243, s97, v207
    v_exp_f32 v242, v242
    v_exp_f32 v243, v243
    v_add_f32 v242, 1.0, v242
    v_add_f32 v243, 1.0, v243
    v_rcp_f32 v242, v242
    s_waitcnt lgkmcnt(2)
    v_mfma_f32_32x32x16_bf16 v[208:223], v[232:235], v[120:123], v[208:223]
    v_rcp_f32 v243, v243
    v_mul_f32 v242, v206, v242
    v_mul_f32 v243, v207, v243
    v_cvt_pk_bf16_f32 v135, v242, v243
    ds_write_b128 v36, v[128:131] offset:0
    ds_write_b128 v36, v[132:135] offset:1024
    s_waitcnt lgkmcnt(2)
    v_mfma_f32_32x32x16_bf16 v[208:223], v[236:239], v[124:127], v[208:223]
    s_waitcnt vmcnt(12)
    s_waitcnt lgkmcnt(0)
    s_barrier
    ds_read_b64_tr_b16 v[224:225], v20 offset:0
    ds_read_b64_tr_b16 v[226:227], v20 offset:512
    ds_read_b64_tr_b16 v[228:229], v20 offset:2048
    ds_read_b64_tr_b16 v[230:231], v20 offset:2560
    ds_read_b64_tr_b16 v[232:233], v20 offset:4096
    ds_read_b64_tr_b16 v[234:235], v20 offset:4608
    ds_read_b128 v[136:139], v37 offset:0
    ds_read_b128 v[140:143], v37 offset:1024
    s_waitcnt lgkmcnt(6)
    v_mfma_f32_32x32x16_bf16 v[192:207], v[224:227], v[64:67], 0
    ds_read_b64_tr_b16 v[236:237], v20 offset:6144
    ds_read_b64_tr_b16 v[238:239], v20 offset:6656
    s_waitcnt lgkmcnt(6)
    v_mfma_f32_32x32x16_bf16 v[192:207], v[228:231], v[68:71], v[192:207]
    ds_read_b64_tr_b16 v[224:225], v20 offset:8192
    ds_read_b64_tr_b16 v[226:227], v20 offset:8704
    s_waitcnt lgkmcnt(6)
    v_mfma_f32_32x32x16_bf16 v[192:207], v[232:235], v[72:75], v[192:207]
    ds_read_b64_tr_b16 v[228:229], v20 offset:10240
    ds_read_b64_tr_b16 v[230:231], v20 offset:10752
    v_mul_f32 v240, s97, v208
    v_mul_f32 v241, s97, v209
    v_exp_f32 v240, v240
    v_exp_f32 v241, v241
    v_add_f32 v240, 1.0, v240
    v_add_f32 v241, 1.0, v241
    v_rcp_f32 v240, v240
    s_add_u32 m0, s84, 32768
    s_add_u32 s87, s86, 0
    s_add_u32 s87, s87, s65
    buffer_load_dwordx4 v8, s[16:19], s87 offen lds
    s_waitcnt lgkmcnt(4)
    v_mfma_f32_32x32x16_bf16 v[192:207], v[236:239], v[76:79], v[192:207]
    ds_read_b64_tr_b16 v[232:233], v20 offset:12288
    ds_read_b64_tr_b16 v[234:235], v20 offset:12800
    v_rcp_f32 v241, v241
    v_mul_f32 v240, v208, v240
    v_mul_f32 v241, v209, v241
    v_cvt_pk_bf16_f32 v144, v240, v241
    v_mul_f32 v242, s97, v210
    v_mul_f32 v243, s97, v211
    v_exp_f32 v242, v242
    s_add_u32 m0, s84, 33792
    s_add_u32 s87, s86, 12288
    s_add_u32 s87, s87, s65
    buffer_load_dwordx4 v8, s[16:19], s87 offen lds
    s_waitcnt lgkmcnt(4)
    v_mfma_f32_32x32x16_bf16 v[192:207], v[224:227], v[80:83], v[192:207]
    ds_read_b64_tr_b16 v[236:237], v20 offset:14336
    ds_read_b64_tr_b16 v[238:239], v20 offset:14848
    v_exp_f32 v243, v243
    v_add_f32 v242, 1.0, v242
    v_add_f32 v243, 1.0, v243
    v_rcp_f32 v242, v242
    v_rcp_f32 v243, v243
    v_mul_f32 v242, v210, v242
    v_mul_f32 v243, v211, v243
    s_add_u32 m0, s84, 34816
    s_add_u32 s87, s86, 24576
    s_add_u32 s87, s87, s65
    buffer_load_dwordx4 v8, s[16:19], s87 offen lds
    s_waitcnt lgkmcnt(4)
    v_mfma_f32_32x32x16_bf16 v[192:207], v[228:231], v[84:87], v[192:207]
    ds_read_b64_tr_b16 v[224:225], v20 offset:16384
    ds_read_b64_tr_b16 v[226:227], v20 offset:16896
    v_cvt_pk_bf16_f32 v145, v242, v243
    v_mul_f32 v240, s97, v212
    v_mul_f32 v241, s97, v213
    v_exp_f32 v240, v240
    v_exp_f32 v241, v241
    v_add_f32 v240, 1.0, v240
    v_add_f32 v241, 1.0, v241
    s_add_u32 m0, s84, 35840
    s_add_u32 s87, s86, 36864
    s_add_u32 s87, s87, s65
    buffer_load_dwordx4 v8, s[16:19], s87 offen lds
    s_waitcnt lgkmcnt(4)
    v_mfma_f32_32x32x16_bf16 v[192:207], v[232:235], v[88:91], v[192:207]
    ds_read_b64_tr_b16 v[228:229], v20 offset:18432
    ds_read_b64_tr_b16 v[230:231], v20 offset:18944
    v_rcp_f32 v240, v240
    v_rcp_f32 v241, v241
    v_mul_f32 v240, v212, v240
    v_mul_f32 v241, v213, v241
    v_cvt_pk_bf16_f32 v146, v240, v241
    v_mul_f32 v242, s97, v214
    v_mul_f32 v243, s97, v215
    s_waitcnt lgkmcnt(4)
    v_mfma_f32_32x32x16_bf16 v[192:207], v[236:239], v[92:95], v[192:207]
    ds_read_b64_tr_b16 v[232:233], v20 offset:20480
    ds_read_b64_tr_b16 v[234:235], v20 offset:20992
    v_exp_f32 v242, v242
    v_exp_f32 v243, v243
    v_add_f32 v242, 1.0, v242
    v_add_f32 v243, 1.0, v243
    v_rcp_f32 v242, v242
    v_rcp_f32 v243, v243
    v_mul_f32 v242, v214, v242
    s_waitcnt lgkmcnt(4)
    v_mfma_f32_32x32x16_bf16 v[192:207], v[224:227], v[96:99], v[192:207]
    ds_read_b64_tr_b16 v[236:237], v20 offset:22528
    ds_read_b64_tr_b16 v[238:239], v20 offset:23040
    v_mul_f32 v243, v215, v243
    v_cvt_pk_bf16_f32 v147, v242, v243
    v_mul_f32 v240, s97, v216
    v_mul_f32 v241, s97, v217
    v_exp_f32 v240, v240
    v_exp_f32 v241, v241
    v_add_f32 v240, 1.0, v240
    s_waitcnt lgkmcnt(4)
    v_mfma_f32_32x32x16_bf16 v[192:207], v[228:231], v[100:103], v[192:207]
    ds_read_b64_tr_b16 v[224:225], v20 offset:24576
    ds_read_b64_tr_b16 v[226:227], v20 offset:25088
    v_add_f32 v241, 1.0, v241
    v_rcp_f32 v240, v240
    v_rcp_f32 v241, v241
    v_mul_f32 v240, v216, v240
    v_mul_f32 v241, v217, v241
    v_cvt_pk_bf16_f32 v148, v240, v241
    v_mul_f32 v242, s97, v218
    s_waitcnt lgkmcnt(4)
    v_mfma_f32_32x32x16_bf16 v[192:207], v[232:235], v[104:107], v[192:207]
    ds_read_b64_tr_b16 v[228:229], v20 offset:26624
    ds_read_b64_tr_b16 v[230:231], v20 offset:27136
    v_mul_f32 v243, s97, v219
    v_exp_f32 v242, v242
    v_exp_f32 v243, v243
    v_add_f32 v242, 1.0, v242
    v_add_f32 v243, 1.0, v243
    v_rcp_f32 v242, v242
    v_rcp_f32 v243, v243
    s_waitcnt lgkmcnt(4)
    v_mfma_f32_32x32x16_bf16 v[192:207], v[236:239], v[108:111], v[192:207]
    ds_read_b64_tr_b16 v[232:233], v20 offset:28672
    ds_read_b64_tr_b16 v[234:235], v20 offset:29184
    v_mul_f32 v242, v218, v242
    v_mul_f32 v243, v219, v243
    v_cvt_pk_bf16_f32 v149, v242, v243
    v_mul_f32 v240, s97, v220
    v_mul_f32 v241, s97, v221
    v_exp_f32 v240, v240
    v_exp_f32 v241, v241
    s_waitcnt lgkmcnt(4)
    v_mfma_f32_32x32x16_bf16 v[192:207], v[224:227], v[112:115], v[192:207]
    ds_read_b64_tr_b16 v[236:237], v20 offset:30720
    ds_read_b64_tr_b16 v[238:239], v20 offset:31232
    v_add_f32 v240, 1.0, v240
    v_add_f32 v241, 1.0, v241
    v_rcp_f32 v240, v240
    v_rcp_f32 v241, v241
    v_mul_f32 v240, v220, v240
    v_mul_f32 v241, v221, v241
    v_cvt_pk_bf16_f32 v150, v240, v241
    s_waitcnt lgkmcnt(4)
    v_mfma_f32_32x32x16_bf16 v[192:207], v[228:231], v[116:119], v[192:207]
    v_mul_f32 v242, s97, v222
    v_mul_f32 v243, s97, v223
    v_exp_f32 v242, v242
    v_exp_f32 v243, v243
    v_add_f32 v242, 1.0, v242
    v_add_f32 v243, 1.0, v243
    v_rcp_f32 v242, v242
    s_waitcnt lgkmcnt(2)
    v_mfma_f32_32x32x16_bf16 v[192:207], v[232:235], v[120:123], v[192:207]
    v_rcp_f32 v243, v243
    v_mul_f32 v242, v222, v242
    v_mul_f32 v243, v223, v243
    v_cvt_pk_bf16_f32 v151, v242, v243
    ds_write_b128 v36, v[144:147] offset:2048
    ds_write_b128 v36, v[148:151] offset:3072
    s_waitcnt lgkmcnt(2)
    v_mfma_f32_32x32x16_bf16 v[192:207], v[236:239], v[124:127], v[192:207]
    s_waitcnt vmcnt(12)
    s_waitcnt lgkmcnt(0)
    s_barrier
    ds_read_b64_tr_b16 v[224:225], v20 offset:32768
    ds_read_b64_tr_b16 v[226:227], v20 offset:33280
    ds_read_b64_tr_b16 v[228:229], v20 offset:34816
    ds_read_b64_tr_b16 v[230:231], v20 offset:35328
    ds_read_b64_tr_b16 v[232:233], v20 offset:36864
    ds_read_b64_tr_b16 v[234:235], v20 offset:37376
    ds_read_b128 v[152:155], v37 offset:2048
    ds_read_b128 v[156:159], v37 offset:3072
    v_mov_b32 v13, 0
    buffer_load_dword v38, v13, s[48:51], 0 offen sc0 sc1
    s_waitcnt lgkmcnt(6)
    v_mfma_f32_32x32x16_bf16 v[208:223], v[224:227], v[64:67], 0
    ds_read_b64_tr_b16 v[236:237], v20 offset:38912
    ds_read_b64_tr_b16 v[238:239], v20 offset:39424
    s_waitcnt lgkmcnt(6)
    v_mfma_f32_32x32x16_bf16 v[208:223], v[228:231], v[68:71], v[208:223]
    ds_read_b64_tr_b16 v[224:225], v20 offset:40960
    ds_read_b64_tr_b16 v[226:227], v20 offset:41472
    s_waitcnt lgkmcnt(6)
    v_mfma_f32_32x32x16_bf16 v[208:223], v[232:235], v[72:75], v[208:223]
    ds_read_b64_tr_b16 v[228:229], v20 offset:43008
    ds_read_b64_tr_b16 v[230:231], v20 offset:43520
    v_mul_f32 v240, s97, v192
    v_mul_f32 v241, s97, v193
    v_exp_f32 v240, v240
    v_exp_f32 v241, v241
    v_add_f32 v240, 1.0, v240
    v_add_f32 v241, 1.0, v241
    v_rcp_f32 v240, v240
    s_add_u32 m0, s84, 65536
    s_add_u32 s87, s86, 0
    s_add_u32 s87, s87, s66
    buffer_load_dwordx4 v8, s[16:19], s87 offen lds
    s_waitcnt lgkmcnt(4)
    v_mfma_f32_32x32x16_bf16 v[208:223], v[236:239], v[76:79], v[208:223]
    ds_read_b64_tr_b16 v[232:233], v20 offset:45056
    ds_read_b64_tr_b16 v[234:235], v20 offset:45568
    v_rcp_f32 v241, v241
    v_mul_f32 v240, v192, v240
    v_mul_f32 v241, v193, v241
    v_cvt_pk_bf16_f32 v160, v240, v241
    v_mul_f32 v242, s97, v194
    v_mul_f32 v243, s97, v195
    v_exp_f32 v242, v242
    s_add_u32 m0, s84, 66560
    s_add_u32 s87, s86, 12288
    s_add_u32 s87, s87, s66
    buffer_load_dwordx4 v8, s[16:19], s87 offen lds
    s_waitcnt lgkmcnt(4)
    v_mfma_f32_32x32x16_bf16 v[208:223], v[224:227], v[80:83], v[208:223]
    ds_read_b64_tr_b16 v[236:237], v20 offset:47104
    ds_read_b64_tr_b16 v[238:239], v20 offset:47616
    v_exp_f32 v243, v243
    v_add_f32 v242, 1.0, v242
    v_add_f32 v243, 1.0, v243
    v_rcp_f32 v242, v242
    v_rcp_f32 v243, v243
    v_mul_f32 v242, v194, v242
    v_mul_f32 v243, v195, v243
    s_add_u32 m0, s84, 67584
    s_add_u32 s87, s86, 24576
    s_add_u32 s87, s87, s66
    buffer_load_dwordx4 v8, s[16:19], s87 offen lds
    s_waitcnt lgkmcnt(4)
    v_mfma_f32_32x32x16_bf16 v[208:223], v[228:231], v[84:87], v[208:223]
    ds_read_b64_tr_b16 v[224:225], v20 offset:49152
    ds_read_b64_tr_b16 v[226:227], v20 offset:49664
    v_cvt_pk_bf16_f32 v161, v242, v243
    v_mul_f32 v240, s97, v196
    v_mul_f32 v241, s97, v197
    v_exp_f32 v240, v240
    v_exp_f32 v241, v241
    v_add_f32 v240, 1.0, v240
    v_add_f32 v241, 1.0, v241
    s_add_u32 m0, s84, 68608
    s_add_u32 s87, s86, 36864
    s_add_u32 s87, s87, s66
    buffer_load_dwordx4 v8, s[16:19], s87 offen lds
    s_waitcnt lgkmcnt(4)
    v_mfma_f32_32x32x16_bf16 v[208:223], v[232:235], v[88:91], v[208:223]
    ds_read_b64_tr_b16 v[228:229], v20 offset:51200
    ds_read_b64_tr_b16 v[230:231], v20 offset:51712
    v_rcp_f32 v240, v240
    v_rcp_f32 v241, v241
    v_mul_f32 v240, v196, v240
    v_mul_f32 v241, v197, v241
    v_cvt_pk_bf16_f32 v162, v240, v241
    v_mul_f32 v242, s97, v198
    v_mul_f32 v243, s97, v199
    s_waitcnt lgkmcnt(4)
    v_mfma_f32_32x32x16_bf16 v[208:223], v[236:239], v[92:95], v[208:223]
    ds_read_b64_tr_b16 v[232:233], v20 offset:53248
    ds_read_b64_tr_b16 v[234:235], v20 offset:53760
    v_exp_f32 v242, v242
    v_exp_f32 v243, v243
    v_add_f32 v242, 1.0, v242
    v_add_f32 v243, 1.0, v243
    v_rcp_f32 v242, v242
    v_rcp_f32 v243, v243
    v_mul_f32 v242, v198, v242
    s_waitcnt lgkmcnt(4)
    v_mfma_f32_32x32x16_bf16 v[208:223], v[224:227], v[96:99], v[208:223]
    ds_read_b64_tr_b16 v[236:237], v20 offset:55296
    ds_read_b64_tr_b16 v[238:239], v20 offset:55808
    v_mul_f32 v243, v199, v243
    v_cvt_pk_bf16_f32 v163, v242, v243
    v_mul_f32 v240, s97, v200
    v_mul_f32 v241, s97, v201
    v_exp_f32 v240, v240
    v_exp_f32 v241, v241
    v_add_f32 v240, 1.0, v240
    s_waitcnt lgkmcnt(4)
    v_mfma_f32_32x32x16_bf16 v[208:223], v[228:231], v[100:103], v[208:223]
    ds_read_b64_tr_b16 v[224:225], v20 offset:57344
    ds_read_b64_tr_b16 v[226:227], v20 offset:57856
    v_add_f32 v241, 1.0, v241
    v_rcp_f32 v240, v240
    v_rcp_f32 v241, v241
    v_mul_f32 v240, v200, v240
    v_mul_f32 v241, v201, v241
    v_cvt_pk_bf16_f32 v164, v240, v241
    v_mul_f32 v242, s97, v202
    s_waitcnt lgkmcnt(4)
    v_mfma_f32_32x32x16_bf16 v[208:223], v[232:235], v[104:107], v[208:223]
    ds_read_b64_tr_b16 v[228:229], v20 offset:59392
    ds_read_b64_tr_b16 v[230:231], v20 offset:59904
    v_mul_f32 v243, s97, v203
    v_exp_f32 v242, v242
    v_exp_f32 v243, v243
    v_add_f32 v242, 1.0, v242
    v_add_f32 v243, 1.0, v243
    v_rcp_f32 v242, v242
    v_rcp_f32 v243, v243
    s_waitcnt lgkmcnt(4)
    v_mfma_f32_32x32x16_bf16 v[208:223], v[236:239], v[108:111], v[208:223]
    ds_read_b64_tr_b16 v[232:233], v20 offset:61440
    ds_read_b64_tr_b16 v[234:235], v20 offset:61952
    v_mul_f32 v242, v202, v242
    v_mul_f32 v243, v203, v243
    v_cvt_pk_bf16_f32 v165, v242, v243
    v_mul_f32 v240, s97, v204
    v_mul_f32 v241, s97, v205
    v_exp_f32 v240, v240
    v_exp_f32 v241, v241
    s_waitcnt lgkmcnt(4)
    v_mfma_f32_32x32x16_bf16 v[208:223], v[224:227], v[112:115], v[208:223]
    ds_read_b64_tr_b16 v[236:237], v20 offset:63488
    ds_read_b64_tr_b16 v[238:239], v20 offset:64000
    v_add_f32 v240, 1.0, v240
    v_add_f32 v241, 1.0, v241
    v_rcp_f32 v240, v240
    v_rcp_f32 v241, v241
    v_mul_f32 v240, v204, v240
    v_mul_f32 v241, v205, v241
    v_cvt_pk_bf16_f32 v166, v240, v241
    s_waitcnt lgkmcnt(4)
    v_mfma_f32_32x32x16_bf16 v[208:223], v[228:231], v[116:119], v[208:223]
    v_mul_f32 v242, s97, v206
    v_mul_f32 v243, s97, v207
    v_exp_f32 v242, v242
    v_exp_f32 v243, v243
    v_add_f32 v242, 1.0, v242
    v_add_f32 v243, 1.0, v243
    v_rcp_f32 v242, v242
    s_waitcnt lgkmcnt(2)
    v_mfma_f32_32x32x16_bf16 v[208:223], v[232:235], v[120:123], v[208:223]
    v_rcp_f32 v243, v243
    v_mul_f32 v242, v206, v242
    v_mul_f32 v243, v207, v243
    v_cvt_pk_bf16_f32 v167, v242, v243
    ds_write_b128 v36, v[160:163] offset:0
    ds_write_b128 v36, v[164:167] offset:1024
    s_waitcnt lgkmcnt(2)
    v_mfma_f32_32x32x16_bf16 v[208:223], v[236:239], v[124:127], v[208:223]
    s_barrier
    s_nop 15
    v_mul_f32 v240, s97, v208
    v_mul_f32 v241, s97, v209
    v_exp_f32 v240, v240
    v_exp_f32 v241, v241
    v_add_f32 v240, 1.0, v240
    v_add_f32 v241, 1.0, v241
    v_rcp_f32 v240, v240
    v_rcp_f32 v241, v241
    v_mul_f32 v240, v208, v240
    v_mul_f32 v241, v209, v241
    v_cvt_pk_bf16_f32 v176, v240, v241
    v_mul_f32 v242, s97, v210
    v_mul_f32 v243, s97, v211
    v_exp_f32 v242, v242
    v_exp_f32 v243, v243
    v_add_f32 v242, 1.0, v242
    v_add_f32 v243, 1.0, v243
    v_rcp_f32 v242, v242
    v_rcp_f32 v243, v243
    v_mul_f32 v242, v210, v242
    v_mul_f32 v243, v211, v243
    v_cvt_pk_bf16_f32 v177, v242, v243
    v_mul_f32 v240, s97, v212
    v_mul_f32 v241, s97, v213
    v_exp_f32 v240, v240
    v_exp_f32 v241, v241
    v_add_f32 v240, 1.0, v240
    v_add_f32 v241, 1.0, v241
    v_rcp_f32 v240, v240
    v_rcp_f32 v241, v241
    v_mul_f32 v240, v212, v240
    v_mul_f32 v241, v213, v241
    v_cvt_pk_bf16_f32 v178, v240, v241
    v_mul_f32 v242, s97, v214
    v_mul_f32 v243, s97, v215
    v_exp_f32 v242, v242
    v_exp_f32 v243, v243
    v_add_f32 v242, 1.0, v242
    v_add_f32 v243, 1.0, v243
    v_rcp_f32 v242, v242
    v_rcp_f32 v243, v243
    v_mul_f32 v242, v214, v242
    v_mul_f32 v243, v215, v243
    v_cvt_pk_bf16_f32 v179, v242, v243
    v_mul_f32 v240, s97, v216
    v_mul_f32 v241, s97, v217
    v_exp_f32 v240, v240
    v_exp_f32 v241, v241
    v_add_f32 v240, 1.0, v240
    v_add_f32 v241, 1.0, v241
    v_rcp_f32 v240, v240
    v_rcp_f32 v241, v241
    v_mul_f32 v240, v216, v240
    v_mul_f32 v241, v217, v241
    v_cvt_pk_bf16_f32 v180, v240, v241
    v_mul_f32 v242, s97, v218
    v_mul_f32 v243, s97, v219
    v_exp_f32 v242, v242
    v_exp_f32 v243, v243
    v_add_f32 v242, 1.0, v242
    v_add_f32 v243, 1.0, v243
    v_rcp_f32 v242, v242
    v_rcp_f32 v243, v243
    v_mul_f32 v242, v218, v242
    v_mul_f32 v243, v219, v243
    v_cvt_pk_bf16_f32 v181, v242, v243
    v_mul_f32 v240, s97, v220
    v_mul_f32 v241, s97, v221
    v_exp_f32 v240, v240
    v_exp_f32 v241, v241
    v_add_f32 v240, 1.0, v240
    v_add_f32 v241, 1.0, v241
    v_rcp_f32 v240, v240
    v_rcp_f32 v241, v241
    v_mul_f32 v240, v220, v240
    v_mul_f32 v241, v221, v241
    v_cvt_pk_bf16_f32 v182, v240, v241
    v_mul_f32 v242, s97, v222
    v_mul_f32 v243, s97, v223
    v_exp_f32 v242, v242
    v_exp_f32 v243, v243
    v_add_f32 v242, 1.0, v242
    v_add_f32 v243, 1.0, v243
    v_rcp_f32 v242, v242
    v_rcp_f32 v243, v243
    v_mul_f32 v242, v222, v242
    v_mul_f32 v243, v223, v243
    v_cvt_pk_bf16_f32 v183, v242, v243
    ds_write_b128 v36, v[176:179] offset:2048
    ds_write_b128 v36, v[180:183] offset:3072
    s_waitcnt vmcnt(13)
    s_waitcnt lgkmcnt(0)
    s_barrier
    ds_read_b64_tr_b16 v[224:225], v52 offset:0
    ds_read_b64_tr_b16 v[226:227], v52 offset:1024
    ds_read_b64_tr_b16 v[228:229], v52 offset:2048
    ds_read_b64_tr_b16 v[230:231], v52 offset:3072
    ds_read_b64_tr_b16 v[232:233], v53 offset:0
    ds_read_b64_tr_b16 v[234:235], v53 offset:1024
    ds_read_b128 v[168:171], v37 offset:0
    ds_read_b128 v[172:175], v37 offset:1024
    ds_read_b128 v[184:187], v37 offset:2048
    ds_read_b128 v[188:191], v37 offset:3072
    s_waitcnt lgkmcnt(8)
    v_mfma_f32_32x32x16_bf16 v[192:207], v[224:227], v[128:131], 0
    ds_read_b64_tr_b16 v[236:237], v53 offset:2048
    ds_read_b64_tr_b16 v[238:239], v53 offset:3072
    s_waitcnt lgkmcnt(8)
    v_mfma_f32_32x32x16_bf16 v[192:207], v[228:231], v[132:135], v[192:207]
    ds_read_b64_tr_b16 v[224:225], v54 offset:0
    ds_read_b64_tr_b16 v[226:227], v54 offset:1024
    s_waitcnt lgkmcnt(8)
    v_mfma_f32_32x32x16_bf16 v[192:207], v[232:235], v[136:139], v[192:207]
    ds_read_b64_tr_b16 v[228:229], v54 offset:2048
    ds_read_b64_tr_b16 v[230:231], v54 offset:3072
    s_add_u32 m0, s84, 98304
    s_add_u32 s87, s86, 0
    s_add_u32 s87, s87, s67
    buffer_load_dwordx4 v8, s[16:19], s87 offen lds
    s_add_u32 m0, s84, 99328
    s_add_u32 s87, s86, 12288
    s_add_u32 s87, s87, s67
    buffer_load_dwordx4 v8, s[16:19], s87 offen lds
    s_add_u32 m0, s84, 100352
    s_add_u32 s87, s86, 24576
    s_add_u32 s87, s87, s67
    buffer_load_dwordx4 v8, s[16:19], s87 offen lds
    s_add_u32 m0, s84, 101376
    s_add_u32 s87, s86, 36864
    s_add_u32 s87, s87, s67
    buffer_load_dwordx4 v8, s[16:19], s87 offen lds
    s_waitcnt vmcnt(13)
    v_and_b32 v105, 1, v26
    v_lshlrev_b32 v105, 4, v105
    v_lshrrev_b64 v[40:41], v105, v[40:41]
    s_waitcnt lgkmcnt(4)
    v_mfma_f32_32x32x16_bf16 v[192:207], v[236:239], v[140:143], v[192:207]
    ds_read_b64_tr_b16 v[232:233], v55 offset:0
    ds_read_b64_tr_b16 v[234:235], v55 offset:1024
    v_lshlrev_b32 v96, 16, v40
    v_and_b32 v97, 0xffff0000, v40
    v_lshlrev_b32 v98, 16, v41
    v_and_b32 v105, 1, v28
    v_lshlrev_b32 v105, 4, v105
    v_lshrrev_b64 v[44:45], v105, v[44:45]
    v_lshlrev_b32 v99, 16, v44
    v_and_b32 v100, 0xffff0000, v44
    s_waitcnt lgkmcnt(4)
    v_mfma_f32_32x32x16_bf16 v[192:207], v[224:227], v[144:147], v[192:207]
    ds_read_b64_tr_b16 v[236:237], v55 offset:2048
    ds_read_b64_tr_b16 v[238:239], v55 offset:3072
    v_lshlrev_b32 v101, 16, v45
    v_sub_f32 v96, v96, v99
    v_cvt_pk_bf16_f32 v96, v96, v96
    v_and_b32 v96, 0xffff0000, v96
    v_sub_f32 v97, v97, v100
    v_cvt_pk_bf16_f32 v97, v97, v97
    v_and_b32 v97, 0xffff0000, v97
    v_sub_f32 v98, v98, v101
    s_waitcnt lgkmcnt(4)
    v_mfma_f32_32x32x16_bf16 v[192:207], v[228:231], v[148:151], v[192:207]
    ds_read_b64_tr_b16 v[224:225], v56 offset:0
    ds_read_b64_tr_b16 v[226:227], v56 offset:1024
    v_cvt_pk_bf16_f32 v98, v98, v98
    v_and_b32 v98, 0xffff0000, v98
    v_mul_f32 v99, v96, v96
    v_cvt_pk_bf16_f32 v99, v99, v99
    v_and_b32 v99, 0xffff0000, v99
    v_mul_f32 v100, v97, v97
    v_cvt_pk_bf16_f32 v100, v100, v100
    v_and_b32 v100, 0xffff0000, v100
    s_waitcnt lgkmcnt(4)
    v_mfma_f32_32x32x16_bf16 v[192:207], v[232:235], v[152:155], v[192:207]
    ds_read_b64_tr_b16 v[228:229], v56 offset:2048
    ds_read_b64_tr_b16 v[230:231], v56 offset:3072
    v_mul_f32 v101, v98, v98
    v_cvt_pk_bf16_f32 v101, v101, v101
    v_and_b32 v101, 0xffff0000, v101
    v_add_f32 v99, v99, v100
    v_add_f32 v99, v99, v101
    v_cvt_pk_bf16_f32 v99, v99, v99
    v_and_b32 v99, 0xffff0000, v99
    v_add_f32 v99, s96, v99
    s_waitcnt lgkmcnt(4)
    v_mfma_f32_32x32x16_bf16 v[192:207], v[236:239], v[156:159], v[192:207]
    ds_read_b64_tr_b16 v[232:233], v57 offset:0
    ds_read_b64_tr_b16 v[234:235], v57 offset:1024
    v_cvt_pk_bf16_f32 v99, v99, v99
    v_and_b32 v99, 0xffff0000, v99
    v_sqrt_f32 v99, v99
    s_nop 0
    v_cvt_pk_bf16_f32 v99, v99, v99
    v_and_b32 v99, 0xffff0000, v99
    v_rcp_f32 v100, v99
    s_nop 0
    s_waitcnt lgkmcnt(4)
    s_waitcnt lgkmcnt(15)
    v_mfma_f32_32x32x16_bf16 v[192:207], v[224:227], v[160:163], v[192:207]
    ds_read_b64_tr_b16 v[236:237], v57 offset:2048
    ds_read_b64_tr_b16 v[238:239], v57 offset:3072
    v_mul_f32 v67, v96, v100
    v_cvt_pk_bf16_f32 v67, v67, v67
    v_and_b32 v67, 0xffff0000, v67
    v_mul_f32 v68, v97, v100
    v_cvt_pk_bf16_f32 v68, v68, v68
    v_and_b32 v68, 0xffff0000, v68
    v_mul_f32 v69, v98, v100
    v_cvt_pk_bf16_f32 v69, v69, v69
    s_waitcnt lgkmcnt(4)
    v_mfma_f32_32x32x16_bf16 v[192:207], v[228:231], v[164:167], v[192:207]
    ds_read_b64_tr_b16 v[224:225], v58 offset:0
    ds_read_b64_tr_b16 v[226:227], v58 offset:1024
    v_and_b32 v69, 0xffff0000, v69
    v_mul_f32 v101, s93, v99
    v_cvt_pk_bf16_f32 v101, v101, v101
    v_and_b32 v101, 0xffff0000, v101
    v_mul_f32 v101, s94, v101
    v_cvt_pk_bf16_f32 v101, v101, v101
    v_and_b32 v101, 0xffff0000, v101
    v_mul_f32 v101, s92, v101
    s_waitcnt lgkmcnt(4)
    v_mfma_f32_32x32x16_bf16 v[192:207], v[232:235], v[168:171], v[192:207]
    ds_read_b64_tr_b16 v[228:229], v58 offset:2048
    ds_read_b64_tr_b16 v[230:231], v58 offset:3072
    v_fract_f32 v101, v101
    v_cos_f32 v101, v101
    s_nop 0
    v_cvt_pk_bf16_f32 v101, v101, v101
    v_and_b32 v101, 0xffff0000, v101
    v_add_f32 v101, 1.0, v101
    v_cvt_pk_bf16_f32 v101, v101, v101
    v_and_b32 v101, 0xffff0000, v101
    s_waitcnt lgkmcnt(4)
    v_mfma_f32_32x32x16_bf16 v[192:207], v[236:239], v[172:175], v[192:207]
    ds_read_b64_tr_b16 v[232:233], v59 offset:0
    ds_read_b64_tr_b16 v[234:235], v59 offset:1024
    v_mul_f32 v101, 0.5, v101
    v_cvt_pk_bf16_f32 v101, v101, v101
    v_and_b32 v101, 0xffff0000, v101
    v_mul_f32 v96, s88, v99
    v_cvt_pk_bf16_f32 v96, v96, v96
    v_and_b32 v96, 0xffff0000, v96
    v_mul_f32 v96, s92, v96
    v_fract_f32 v96, v96
    s_waitcnt lgkmcnt(4)
    v_mfma_f32_32x32x16_bf16 v[192:207], v[224:227], v[176:179], v[192:207]
    ds_read_b64_tr_b16 v[236:237], v59 offset:2048
    ds_read_b64_tr_b16 v[238:239], v59 offset:3072
    v_sin_f32 v96, v96
    s_nop 0
    v_cvt_pk_bf16_f32 v96, v96, v96
    v_and_b32 v96, 0xffff0000, v96
    v_mul_f32 v96, v96, v100
    v_cvt_pk_bf16_f32 v96, v96, v96
    v_and_b32 v96, 0xffff0000, v96
    v_mul_f32 v96, v96, v101
    s_waitcnt lgkmcnt(4)
    v_mfma_f32_32x32x16_bf16 v[192:207], v[228:231], v[180:183], v[192:207]
    v_mul_f32 v97, s89, v99
    v_cvt_pk_bf16_f32 v97, v97, v97
    v_and_b32 v97, 0xffff0000, v97
    v_mul_f32 v97, s92, v97
    v_fract_f32 v97, v97
    v_sin_f32 v97, v97
    s_nop 0
    v_cvt_pk_bf16_f32 v97, v97, v97
    s_waitcnt lgkmcnt(2)
    v_mfma_f32_32x32x16_bf16 v[192:207], v[232:235], v[184:187], v[192:207]
    v_and_b32 v97, 0xffff0000, v97
    v_mul_f32 v97, v97, v100
    v_cvt_pk_bf16_f32 v97, v97, v97
    v_and_b32 v97, 0xffff0000, v97
    v_mul_f32 v97, v97, v101
    v_mul_f32 v98, s90, v99
    v_cvt_pk_bf16_f32 v98, v98, v98
    v_and_b32 v98, 0xffff0000, v98
    s_waitcnt lgkmcnt(0)
    v_mfma_f32_32x32x16_bf16 v[192:207], v[236:239], v[188:191], v[192:207]
    v_mul_f32 v98, s92, v98
    v_fract_f32 v98, v98
    v_sin_f32 v98, v98
    s_nop 0
    v_cvt_pk_bf16_f32 v98, v98, v98
    v_and_b32 v98, 0xffff0000, v98
    v_mul_f32 v98, v98, v100
    v_cvt_pk_bf16_f32 v98, v98, v98
    s_waitcnt vmcnt(9)
    s_barrier
    ds_read_b64_tr_b16 v[224:225], v52 offset:32768
    ds_read_b64_tr_b16 v[226:227], v52 offset:33792
    ds_read_b64_tr_b16 v[228:229], v52 offset:34816
    ds_read_b64_tr_b16 v[230:231], v52 offset:35840
    ds_read_b64_tr_b16 v[232:233], v53 offset:32768
    ds_read_b64_tr_b16 v[234:235], v53 offset:33792
    v_add_u32 v84, 0x10000, v52
    v_add_u32 v85, 0x10000, v53
    v_add_u32 v86, 0x10000, v54
    v_add_u32 v87, 0x10000, v55
    v_add_u32 v88, 0x10000, v56
    v_add_u32 v89, 0x10000, v57
    v_add_u32 v90, 0x10000, v58
    v_add_u32 v91, 0x10000, v59
    s_waitcnt lgkmcnt(4)
    v_mfma_f32_32x32x16_bf16 v[208:223], v[224:227], v[128:131], 0
    ds_read_b64_tr_b16 v[236:237], v53 offset:34816
    ds_read_b64_tr_b16 v[238:239], v53 offset:35840
    s_waitcnt lgkmcnt(4)
    v_mfma_f32_32x32x16_bf16 v[208:223], v[228:231], v[132:135], v[208:223]
    ds_read_b64_tr_b16 v[224:225], v54 offset:32768
    ds_read_b64_tr_b16 v[226:227], v54 offset:33792
    s_waitcnt lgkmcnt(4)
    v_mfma_f32_32x32x16_bf16 v[208:223], v[232:235], v[136:139], v[208:223]
    ds_read_b64_tr_b16 v[228:229], v54 offset:34816
    ds_read_b64_tr_b16 v[230:231], v54 offset:35840
    v_cvt_pk_bf16_f32 v240, v192, v193
    v_cvt_pk_bf16_f32 v241, v194, v195
    v_cvt_pk_bf16_f32 v242, v196, v197
    v_cvt_pk_bf16_f32 v243, v198, v199
    ds_write_b128 v32, v[240:243]
    v_cvt_pk_bf16_f32 v244, v200, v201
    v_cvt_pk_bf16_f32 v245, v202, v203
    v_cvt_pk_bf16_f32 v246, v204, v205
    s_waitcnt lgkmcnt(5)
    v_mfma_f32_32x32x16_bf16 v[208:223], v[236:239], v[140:143], v[208:223]
    ds_read_b64_tr_b16 v[232:233], v55 offset:32768
    ds_read_b64_tr_b16 v[234:235], v55 offset:33792
    v_cvt_pk_bf16_f32 v247, v206, v207
    ds_write_b128 v33, v[244:247]
    ds_read_b128 v[248:251], v34 offset:0
    ds_read_b128 v[252:255], v34 offset:1024
    s_nop 0
    s_nop 0
    s_nop 0
    s_waitcnt lgkmcnt(1)
    buffer_store_dwordx4 v[248:251], v6, s[20:23], s69 offen sc1
    s_waitcnt lgkmcnt(8)
    v_mfma_f32_32x32x16_bf16 v[208:223], v[224:227], v[144:147], v[208:223]
    ds_read_b64_tr_b16 v[236:237], v55 offset:34816
    ds_read_b64_tr_b16 v[238:239], v55 offset:35840
    s_waitcnt lgkmcnt(2)
    buffer_store_dwordx4 v[252:255], v6, s[20:23], s70 offen sc1
    v_and_b32 v98, 0xffff0000, v98
    v_mul_f32 v98, v98, v101
    v_mul_f32 v102, s91, v99
    v_cvt_pk_bf16_f32 v102, v102, v102
    v_and_b32 v102, 0xffff0000, v102
    v_mul_f32 v102, s92, v102
    v_fract_f32 v102, v102
    s_waitcnt lgkmcnt(8)
    v_mfma_f32_32x32x16_bf16 v[208:223], v[228:231], v[148:151], v[208:223]
    ds_read_b64_tr_b16 v[224:225], v56 offset:32768
    ds_read_b64_tr_b16 v[226:227], v56 offset:33792
    v_sin_f32 v102, v102
    s_nop 0
    v_cvt_pk_bf16_f32 v102, v102, v102
    v_and_b32 v102, 0xffff0000, v102
    v_mul_f32 v102, v102, v100
    v_cvt_pk_bf16_f32 v102, v102, v102
    v_and_b32 v102, 0xffff0000, v102
    v_mul_f32 v102, v102, v101
    s_waitcnt lgkmcnt(7)
    v_mfma_f32_32x32x16_bf16 v[208:223], v[232:235], v[152:155], v[208:223]
    ds_read_b64_tr_b16 v[228:229], v56 offset:34816
    ds_read_b64_tr_b16 v[230:231], v56 offset:35840
    v_cvt_pk_bf16_f32 v65, v96, v97
    v_cvt_pk_bf16_f32 v66, v98, v102
    v_mov_b32 v64, v26
    v_mov_b32 v70, v28
    v_mov_b32 v71, 0
    v_lshlrev_b32 v103, 2, v28
    v_cmp_gt_f32 vcc, s95, v99
    v_cmp_gt_u32 s[98:99], s38, v30
    s_waitcnt lgkmcnt(4)
    v_mfma_f32_32x32x16_bf16 v[208:223], v[236:239], v[156:159], v[208:223]
    ds_read_b64_tr_b16 v[232:233], v57 offset:32768
    ds_read_b64_tr_b16 v[234:235], v57 offset:33792
    v_mov_b32 v104, 1
    s_nop 0
    s_and_b64 vcc, vcc, s[98:99]
    v_cndmask_b32 v103, v18, v103, vcc
    v_and_b32 v115, 1, v27
    v_lshlrev_b32 v115, 4, v115
    v_lshrrev_b64 v[42:43], v115, v[42:43]
    v_lshlrev_b32 v106, 16, v42
    s_waitcnt lgkmcnt(4)
    v_mfma_f32_32x32x16_bf16 v[208:223], v[224:227], v[160:163], v[208:223]
    ds_read_b64_tr_b16 v[236:237], v57 offset:34816
    ds_read_b64_tr_b16 v[238:239], v57 offset:35840
    v_and_b32 v107, 0xffff0000, v42
    v_lshlrev_b32 v108, 16, v43
    v_and_b32 v115, 1, v29
    v_lshlrev_b32 v115, 4, v115
    v_lshrrev_b64 v[46:47], v115, v[46:47]
    v_lshlrev_b32 v109, 16, v46
    v_and_b32 v110, 0xffff0000, v46
    v_lshlrev_b32 v111, 16, v47
    s_waitcnt lgkmcnt(4)
    v_mfma_f32_32x32x16_bf16 v[208:223], v[228:231], v[164:167], v[208:223]
    ds_read_b64_tr_b16 v[224:225], v58 offset:32768
    ds_read_b64_tr_b16 v[226:227], v58 offset:33792
    v_sub_f32 v106, v106, v109
    v_cvt_pk_bf16_f32 v106, v106, v106
    v_and_b32 v106, 0xffff0000, v106
    v_sub_f32 v107, v107, v110
    v_cvt_pk_bf16_f32 v107, v107, v107
    v_and_b32 v107, 0xffff0000, v107
    v_sub_f32 v108, v108, v111
    v_cvt_pk_bf16_f32 v108, v108, v108
    s_waitcnt lgkmcnt(4)
    v_mfma_f32_32x32x16_bf16 v[208:223], v[232:235], v[168:171], v[208:223]
    ds_read_b64_tr_b16 v[228:229], v58 offset:34816
    ds_read_b64_tr_b16 v[230:231], v58 offset:35840
    v_and_b32 v108, 0xffff0000, v108
    v_mul_f32 v109, v106, v106
    v_cvt_pk_bf16_f32 v109, v109, v109
    v_and_b32 v109, 0xffff0000, v109
    v_mul_f32 v110, v107, v107
    v_cvt_pk_bf16_f32 v110, v110, v110
    v_and_b32 v110, 0xffff0000, v110
    v_mul_f32 v111, v108, v108
    s_waitcnt lgkmcnt(4)
    v_mfma_f32_32x32x16_bf16 v[208:223], v[236:239], v[172:175], v[208:223]
    ds_read_b64_tr_b16 v[232:233], v59 offset:32768
    ds_read_b64_tr_b16 v[234:235], v59 offset:33792
    v_cvt_pk_bf16_f32 v111, v111, v111
    v_and_b32 v111, 0xffff0000, v111
    v_add_f32 v109, v109, v110
    v_add_f32 v109, v109, v111
    v_cvt_pk_bf16_f32 v109, v109, v109
    v_and_b32 v109, 0xffff0000, v109
    v_add_f32 v109, s96, v109
    v_cvt_pk_bf16_f32 v109, v109, v109
    s_waitcnt lgkmcnt(4)
    v_mfma_f32_32x32x16_bf16 v[208:223], v[224:227], v[176:179], v[208:223]
    ds_read_b64_tr_b16 v[236:237], v59 offset:34816
    ds_read_b64_tr_b16 v[238:239], v59 offset:35840
    v_and_b32 v109, 0xffff0000, v109
    v_sqrt_f32 v109, v109
    s_nop 0
    v_cvt_pk_bf16_f32 v109, v109, v109
    v_and_b32 v109, 0xffff0000, v109
    v_rcp_f32 v110, v109
    s_nop 0
    v_mul_f32 v75, v106, v110
    s_waitcnt lgkmcnt(4)
    v_mfma_f32_32x32x16_bf16 v[208:223], v[228:231], v[180:183], v[208:223]
    v_cvt_pk_bf16_f32 v75, v75, v75
    v_and_b32 v75, 0xffff0000, v75
    v_mul_f32 v76, v107, v110
    v_cvt_pk_bf16_f32 v76, v76, v76
    v_and_b32 v76, 0xffff0000, v76
    v_mul_f32 v77, v108, v110
    v_cvt_pk_bf16_f32 v77, v77, v77
    v_and_b32 v77, 0xffff0000, v77
    s_waitcnt lgkmcnt(2)
    v_mfma_f32_32x32x16_bf16 v[208:223], v[232:235], v[184:187], v[208:223]
    v_mul_f32 v111, s93, v109
    v_cvt_pk_bf16_f32 v111, v111, v111
    v_and_b32 v111, 0xffff0000, v111
    v_mul_f32 v111, s94, v111
    v_cvt_pk_bf16_f32 v111, v111, v111
    v_and_b32 v111, 0xffff0000, v111
    v_mul_f32 v111, s92, v111
    v_fract_f32 v111, v111
    s_waitcnt lgkmcnt(0)
    v_mfma_f32_32x32x16_bf16 v[208:223], v[236:239], v[188:191], v[208:223]
    v_cos_f32 v111, v111
    s_nop 0
    v_cvt_pk_bf16_f32 v111, v111, v111
    v_and_b32 v111, 0xffff0000, v111
    v_add_f32 v111, 1.0, v111
    v_cvt_pk_bf16_f32 v111, v111, v111
    v_and_b32 v111, 0xffff0000, v111
    v_mul_f32 v111, 0.5, v111
    s_waitcnt vmcnt(6)
    s_barrier
    ds_read_b64_tr_b16 v[224:225], v84 offset:0
    ds_read_b64_tr_b16 v[226:227], v84 offset:1024
    ds_read_b64_tr_b16 v[228:229], v84 offset:2048
    ds_read_b64_tr_b16 v[230:231], v84 offset:3072
    ds_read_b64_tr_b16 v[232:233], v85 offset:0
    ds_read_b64_tr_b16 v[234:235], v85 offset:1024
    s_waitcnt lgkmcnt(4)
    v_mfma_f32_32x32x16_bf16 v[192:207], v[224:227], v[128:131], 0
    ds_read_b64_tr_b16 v[236:237], v85 offset:2048
    ds_read_b64_tr_b16 v[238:239], v85 offset:3072
    s_waitcnt lgkmcnt(4)
    v_mfma_f32_32x32x16_bf16 v[192:207], v[228:231], v[132:135], v[192:207]
    ds_read_b64_tr_b16 v[224:225], v86 offset:0
    ds_read_b64_tr_b16 v[226:227], v86 offset:1024
    s_waitcnt lgkmcnt(4)
    v_mfma_f32_32x32x16_bf16 v[192:207], v[232:235], v[136:139], v[192:207]
    ds_read_b64_tr_b16 v[228:229], v86 offset:2048
    ds_read_b64_tr_b16 v[230:231], v86 offset:3072
    v_cvt_pk_bf16_f32 v240, v208, v209
    v_cvt_pk_bf16_f32 v241, v210, v211
    v_cvt_pk_bf16_f32 v242, v212, v213
    v_cvt_pk_bf16_f32 v243, v214, v215
    ds_write_b128 v32, v[240:243]
    v_cvt_pk_bf16_f32 v244, v216, v217
    v_cvt_pk_bf16_f32 v245, v218, v219
    v_cvt_pk_bf16_f32 v246, v220, v221
    s_waitcnt lgkmcnt(5)
    v_mfma_f32_32x32x16_bf16 v[192:207], v[236:239], v[140:143], v[192:207]
    ds_read_b64_tr_b16 v[232:233], v87 offset:0
    ds_read_b64_tr_b16 v[234:235], v87 offset:1024
    v_cvt_pk_bf16_f32 v247, v222, v223
    ds_write_b128 v33, v[244:247]
    ds_read_b128 v[248:251], v34 offset:0
    ds_read_b128 v[252:255], v34 offset:1024
    s_nop 0
    s_nop 0
    s_nop 0
    s_waitcnt lgkmcnt(1)
    buffer_store_dwordx4 v[248:251], v6, s[20:23], s71 offen sc1
    s_waitcnt lgkmcnt(8)
    v_mfma_f32_32x32x16_bf16 v[192:207], v[224:227], v[144:147], v[192:207]
    ds_read_b64_tr_b16 v[236:237], v87 offset:2048
    ds_read_b64_tr_b16 v[238:239], v87 offset:3072
    s_waitcnt lgkmcnt(2)
    buffer_store_dwordx4 v[252:255], v6, s[20:23], s72 offen sc1
    v_cvt_pk_bf16_f32 v111, v111, v111
    v_and_b32 v111, 0xffff0000, v111
    v_mul_f32 v106, s88, v109
    v_cvt_pk_bf16_f32 v106, v106, v106
    v_and_b32 v106, 0xffff0000, v106
    v_mul_f32 v106, s92, v106
    v_fract_f32 v106, v106
    s_waitcnt lgkmcnt(8)
    v_mfma_f32_32x32x16_bf16 v[192:207], v[228:231], v[148:151], v[192:207]
    ds_read_b64_tr_b16 v[224:225], v88 offset:0
    ds_read_b64_tr_b16 v[226:227], v88 offset:1024
    v_sin_f32 v106, v106
    s_nop 0
    v_cvt_pk_bf16_f32 v106, v106, v106
    v_and_b32 v106, 0xffff0000, v106
    v_mul_f32 v106, v106, v110
    v_cvt_pk_bf16_f32 v106, v106, v106
    v_and_b32 v106, 0xffff0000, v106
    v_mul_f32 v106, v106, v111
    s_waitcnt lgkmcnt(7)
    v_mfma_f32_32x32x16_bf16 v[192:207], v[232:235], v[152:155], v[192:207]
    ds_read_b64_tr_b16 v[228:229], v88 offset:2048
    ds_read_b64_tr_b16 v[230:231], v88 offset:3072
    v_mul_f32 v107, s89, v109
    v_cvt_pk_bf16_f32 v107, v107, v107
    v_and_b32 v107, 0xffff0000, v107
    v_mul_f32 v107, s92, v107
    v_fract_f32 v107, v107
    v_sin_f32 v107, v107
    s_nop 0
    v_cvt_pk_bf16_f32 v107, v107, v107
    s_waitcnt lgkmcnt(4)
    v_mfma_f32_32x32x16_bf16 v[192:207], v[236:239], v[156:159], v[192:207]
    ds_read_b64_tr_b16 v[232:233], v89 offset:0
    ds_read_b64_tr_b16 v[234:235], v89 offset:1024
    v_and_b32 v107, 0xffff0000, v107
    v_mul_f32 v107, v107, v110
    v_cvt_pk_bf16_f32 v107, v107, v107
    v_and_b32 v107, 0xffff0000, v107
    v_mul_f32 v107, v107, v111
    v_mul_f32 v108, s90, v109
    v_cvt_pk_bf16_f32 v108, v108, v108
    v_and_b32 v108, 0xffff0000, v108
    s_waitcnt lgkmcnt(4)
    v_mfma_f32_32x32x16_bf16 v[192:207], v[224:227], v[160:163], v[192:207]
    ds_read_b64_tr_b16 v[236:237], v89 offset:2048
    ds_read_b64_tr_b16 v[238:239], v89 offset:3072
    v_mul_f32 v108, s92, v108
    v_fract_f32 v108, v108
    v_sin_f32 v108, v108
    s_nop 0
    v_cvt_pk_bf16_f32 v108, v108, v108
    v_and_b32 v108, 0xffff0000, v108
    v_mul_f32 v108, v108, v110
    v_cvt_pk_bf16_f32 v108, v108, v108
    s_waitcnt lgkmcnt(4)
    v_mfma_f32_32x32x16_bf16 v[192:207], v[228:231], v[164:167], v[192:207]
    ds_read_b64_tr_b16 v[224:225], v90 offset:0
    ds_read_b64_tr_b16 v[226:227], v90 offset:1024
    v_and_b32 v108, 0xffff0000, v108
    v_mul_f32 v108, v108, v111
    v_mul_f32 v112, s91, v109
    v_cvt_pk_bf16_f32 v112, v112, v112
    v_and_b32 v112, 0xffff0000, v112
    v_mul_f32 v112, s92, v112
    v_fract_f32 v112, v112
    v_sin_f32 v112, v112
    s_waitcnt lgkmcnt(4)
    v_mfma_f32_32x32x16_bf16 v[192:207], v[232:235], v[168:171], v[192:207]
    ds_read_b64_tr_b16 v[228:229], v90 offset:2048
    ds_read_b64_tr_b16 v[230:231], v90 offset:3072
    s_nop 0
    v_cvt_pk_bf16_f32 v112, v112, v112
    v_and_b32 v112, 0xffff0000, v112
    v_mul_f32 v112, v112, v110
    v_cvt_pk_bf16_f32 v112, v112, v112
    v_and_b32 v112, 0xffff0000, v112
    v_mul_f32 v112, v112, v111
    v_cvt_pk_bf16_f32 v73, v106, v107
    s_waitcnt lgkmcnt(4)
    v_mfma_f32_32x32x16_bf16 v[192:207], v[236:239], v[172:175], v[192:207]
    ds_read_b64_tr_b16 v[232:233], v91 offset:0
    ds_read_b64_tr_b16 v[234:235], v91 offset:1024
    v_cvt_pk_bf16_f32 v74, v108, v112
    v_mov_b32 v72, v27
    v_mov_b32 v78, v29
    v_mov_b32 v79, 0
    v_lshlrev_b32 v113, 2, v29
    v_cmp_gt_f32 vcc, s95, v109
    v_cmp_gt_u32 s[98:99], s38, v31
    v_mov_b32 v114, 1
    s_waitcnt lgkmcnt(4)
    v_mfma_f32_32x32x16_bf16 v[192:207], v[224:227], v[176:179], v[192:207]
    ds_read_b64_tr_b16 v[236:237], v91 offset:2048
    ds_read_b64_tr_b16 v[238:239], v91 offset:3072
    s_nop 0
    s_and_b64 vcc, vcc, s[98:99]
    v_cndmask_b32 v113, v18, v113, vcc
    s_waitcnt lgkmcnt(4)
    v_mfma_f32_32x32x16_bf16 v[192:207], v[228:231], v[180:183], v[192:207]
    s_waitcnt lgkmcnt(2)
    v_mfma_f32_32x32x16_bf16 v[192:207], v[232:235], v[184:187], v[192:207]
    s_waitcnt lgkmcnt(0)
    v_mfma_f32_32x32x16_bf16 v[192:207], v[236:239], v[188:191], v[192:207]
    s_waitcnt vmcnt(4)
    s_barrier
    ds_read_b64_tr_b16 v[224:225], v84 offset:32768
    ds_read_b64_tr_b16 v[226:227], v84 offset:33792
    ds_read_b64_tr_b16 v[228:229], v84 offset:34816
    ds_read_b64_tr_b16 v[230:231], v84 offset:35840
    ds_read_b64_tr_b16 v[232:233], v85 offset:32768
    ds_read_b64_tr_b16 v[234:235], v85 offset:33792
    s_waitcnt vmcnt(12)
K1_poll:
    v_readfirstlane_b32 s82, v38
    s_cmp_ge_u32 s82, 16
    s_cbranch_scc1 K1_polled
    s_sleep 4
    v_mov_b32 v13, 0
    buffer_load_dword v38, v13, s[48:51], 0 offen sc0 sc1
    s_waitcnt vmcnt(0)
    s_branch K1_poll
K1_polled:
    buffer_atomic_add v104, v103, s[28:31], 0 offen sc0 sc1
    buffer_atomic_add v114, v113, s[28:31], 0 offen sc0 sc1
    s_waitcnt lgkmcnt(4)
    v_mfma_f32_32x32x16_bf16 v[208:223], v[224:227], v[128:131], 0
    ds_read_b64_tr_b16 v[236:237], v85 offset:34816
    ds_read_b64_tr_b16 v[238:239], v85 offset:35840
    s_waitcnt lgkmcnt(4)
    v_mfma_f32_32x32x16_bf16 v[208:223], v[228:231], v[132:135], v[208:223]
    ds_read_b64_tr_b16 v[224:225], v86 offset:32768
    ds_read_b64_tr_b16 v[226:227], v86 offset:33792
    s_waitcnt lgkmcnt(4)
    v_mfma_f32_32x32x16_bf16 v[208:223], v[232:235], v[136:139], v[208:223]
    ds_read_b64_tr_b16 v[228:229], v86 offset:34816
    ds_read_b64_tr_b16 v[230:231], v86 offset:35840
    v_cvt_pk_bf16_f32 v240, v192, v193
    v_cvt_pk_bf16_f32 v241, v194, v195
    v_cvt_pk_bf16_f32 v242, v196, v197
    v_cvt_pk_bf16_f32 v243, v198, v199
    ds_write_b128 v32, v[240:243]
    v_cvt_pk_bf16_f32 v244, v200, v201
    v_cvt_pk_bf16_f32 v245, v202, v203
    v_cvt_pk_bf16_f32 v246, v204, v205
    s_waitcnt lgkmcnt(5)
    v_mfma_f32_32x32x16_bf16 v[208:223], v[236:239], v[140:143], v[208:223]
    ds_read_b64_tr_b16 v[232:233], v87 offset:32768
    ds_read_b64_tr_b16 v[234:235], v87 offset:33792
    v_cvt_pk_bf16_f32 v247, v206, v207
    ds_write_b128 v33, v[244:247]
    ds_read_b128 v[248:251], v34 offset:0
    ds_read_b128 v[252:255], v34 offset:1024
    s_nop 0
    s_nop 0
    s_nop 0
    s_waitcnt lgkmcnt(1)
    buffer_store_dwordx4 v[248:251], v6, s[20:23], s73 offen sc1
    s_waitcnt lgkmcnt(8)
    v_mfma_f32_32x32x16_bf16 v[208:223], v[224:227], v[144:147], v[208:223]
    ds_read_b64_tr_b16 v[236:237], v87 offset:34816
    ds_read_b64_tr_b16 v[238:239], v87 offset:35840
    s_waitcnt lgkmcnt(2)
    buffer_store_dwordx4 v[252:255], v6, s[20:23], s74 offen sc1
    s_waitcnt lgkmcnt(8)
    v_mfma_f32_32x32x16_bf16 v[208:223], v[228:231], v[148:151], v[208:223]
    ds_read_b64_tr_b16 v[224:225], v88 offset:32768
    ds_read_b64_tr_b16 v[226:227], v88 offset:33792
    s_waitcnt lgkmcnt(7)
    v_mfma_f32_32x32x16_bf16 v[208:223], v[232:235], v[152:155], v[208:223]
    ds_read_b64_tr_b16 v[228:229], v88 offset:34816
    ds_read_b64_tr_b16 v[230:231], v88 offset:35840
    s_waitcnt lgkmcnt(4)
    v_mfma_f32_32x32x16_bf16 v[208:223], v[236:239], v[156:159], v[208:223]
    ds_read_b64_tr_b16 v[232:233], v89 offset:32768
    ds_read_b64_tr_b16 v[234:235], v89 offset:33792
    s_waitcnt lgkmcnt(4)
    v_mfma_f32_32x32x16_bf16 v[208:223], v[224:227], v[160:163], v[208:223]
    ds_read_b64_tr_b16 v[236:237], v89 offset:34816
    ds_read_b64_tr_b16 v[238:239], v89 offset:35840
    s_waitcnt lgkmcnt(4)
    v_mfma_f32_32x32x16_bf16 v[208:223], v[228:231], v[164:167], v[208:223]
    ds_read_b64_tr_b16 v[224:225], v90 offset:32768
    ds_read_b64_tr_b16 v[226:227], v90 offset:33792
    s_waitcnt lgkmcnt(4)
    v_mfma_f32_32x32x16_bf16 v[208:223], v[232:235], v[168:171], v[208:223]
    ds_read_b64_tr_b16 v[228:229], v90 offset:34816
    ds_read_b64_tr_b16 v[230:231], v90 offset:35840
    s_waitcnt lgkmcnt(4)
    v_mfma_f32_32x32x16_bf16 v[208:223], v[236:239], v[172:175], v[208:223]
    ds_read_b64_tr_b16 v[232:233], v91 offset:32768
    ds_read_b64_tr_b16 v[234:235], v91 offset:33792
    s_waitcnt lgkmcnt(4)
    v_mfma_f32_32x32x16_bf16 v[208:223], v[224:227], v[176:179], v[208:223]
    ds_read_b64_tr_b16 v[236:237], v91 offset:34816
    ds_read_b64_tr_b16 v[238:239], v91 offset:35840
    s_waitcnt lgkmcnt(4)
    v_mfma_f32_32x32x16_bf16 v[208:223], v[228:231], v[180:183], v[208:223]
    s_waitcnt lgkmcnt(2)
    v_mfma_f32_32x32x16_bf16 v[208:223], v[232:235], v[184:187], v[208:223]
    s_waitcnt lgkmcnt(0)
    v_mfma_f32_32x32x16_bf16 v[208:223], v[236:239], v[188:191], v[208:223]
    s_nop 15
    v_cvt_pk_bf16_f32 v240, v208, v209
    v_cvt_pk_bf16_f32 v241, v210, v211
    v_cvt_pk_bf16_f32 v242, v212, v213
    v_cvt_pk_bf16_f32 v243, v214, v215
    ds_write_b128 v32, v[240:243]
    v_cvt_pk_bf16_f32 v244, v216, v217
    v_cvt_pk_bf16_f32 v245, v218, v219
    v_cvt_pk_bf16_f32 v246, v220, v221
    v_cvt_pk_bf16_f32 v247, v222, v223
    ds_write_b128 v33, v[244:247]
    ds_read_b128 v[248:251], v34 offset:0
    ds_read_b128 v[252:255], v34 offset:1024
    s_nop 0
    s_nop 0
    s_nop 0
    s_waitcnt lgkmcnt(1)
    buffer_store_dwordx4 v[248:251], v6, s[20:23], s75 offen sc1
    s_waitcnt lgkmcnt(0)
    buffer_store_dwordx4 v[252:255], v6, s[20:23], s76 offen sc1
    s_waitcnt vmcnt(4)
    v_cmp_gt_u32 vcc, v18, v103
    v_cmp_gt_u32 s[82:83], 32, v104
    v_lshlrev_b32 v2, 10, v28
    v_lshl_add_u32 v2, v104, 5, v2
    s_and_b64 s[84:85], vcc, s[82:83]
    s_andn2_b64 s[86:87], vcc, s[82:83]
    v_cndmask_b32 v2, v18, v2, s[84:85]
    buffer_store_dwordx4 v[64:67], v2, s[32:35], 0 offen
    buffer_store_dwordx4 v[68:71], v2, s[32:35], 0 offen offset:16
    s_cmp_eq_u64 s[86:87], 0
    s_cbranch_scc1 K1_noovf0
    s_mov_b64 exec, s[86:87]
    v_mov_b32 v2, 40000
    v_mov_b32 v4, 1
    buffer_atomic_add v4, v2, s[28:31], 0 offen sc0 sc1
    s_waitcnt vmcnt(0)
    v_lshlrev_b32 v2, 5, v4
    buffer_store_dwordx4 v[64:67], v2, s[44:47], 0 offen
    buffer_store_dwordx4 v[68:71], v2, s[44:47], 0 offen offset:16
    s_mov_b64 exec, -1
K1_noovf0:
    v_cmp_gt_u32 vcc, v18, v113
    v_cmp_gt_u32 s[82:83], 32, v114
    v_lshlrev_b32 v2, 10, v29
    v_lshl_add_u32 v2, v114, 5, v2
    s_and_b64 s[84:85], vcc, s[82:83]
    s_andn2_b64 s[86:87], vcc, s[82:83]
    v_cndmask_b32 v2, v18, v2, s[84:85]
    buffer_store_dwordx4 v[72:75], v2, s[32:35], 0 offen
    buffer_store_dwordx4 v[76:79], v2, s[32:35], 0 offen offset:16
    s_cmp_eq_u64 s[86:87], 0
    s_cbranch_scc1 K1_noovf1
    s_mov_b64 exec, s[86:87]
    v_mov_b32 v2, 40000
    v_mov_b32 v4, 1
    buffer_atomic_add v4, v2, s[28:31], 0 offen sc0 sc1
    s_waitcnt vmcnt(0)
    v_lshlrev_b32 v2, 5, v4
    buffer_store_dwordx4 v[72:75], v2, s[44:47], 0 offen
    buffer_store_dwordx4 v[76:79], v2, s[44:47], 0 offen offset:16
    s_mov_b64 exec, -1
K1_noovf1:
    s_cmp_lg_u32 s2, 16
    s_cbranch_scc1 K1_nopack2
    s_cmp_ge_u32 s4, 3
    s_cbranch_scc1 K1_nopack2
    s_add_u32 s56, s78, 16842752
    s_addc_u32 s57, s79, 0
    s_and_b32 s57, s57, 0xffff
    s_mov_b32 s58, 6144
    s_mov_b32 s59, 0x20000
    s_mov_b32 s82, 0x05040100
    s_mov_b32 s83, 0x07060302
    s_lshl_b32 s7, s4, 11
    v_lshl_add_u32 v2, v1, 4, s7
    v_perm_b32 v20, v50, v48, s82
    v_perm_b32 v21, v50, v48, s83
    v_perm_b32 v22, v51, v49, s82
    v_perm_b32 v23, v51, v49, s83
    buffer_store_dwordx4 v[20:23], v2, s[56:59], 0 offen offset:0
    v_perm_b32 v24, v62, v60, s82
    v_perm_b32 v25, v62, v60, s83
    v_perm_b32 v26, v63, v61, s82
    v_perm_b32 v27, v63, v61, s83
    buffer_store_dwordx4 v[24:27], v2, s[56:59], 0 offen offset:1024
K1_nopack2:
K1_end:
    s_endpgm
.globl gather_scatter__molecular_angular_painn__graph_kernel
.p2align 8
.type gather_scatter__molecular_angular_painn__graph_kernel,@function
gather_scatter__molecular_angular_painn__graph_kernel:
    s_cmp_ge_u32 s2, 2500
    s_cbranch_scc1 K2_end
    s_load_dwordx2 s[4:5], s[0:1], 0
    s_load_dwordx2 s[6:7], s[0:1], 64
    s_load_dwordx2 s[8:9], s[0:1], 80
    v_lshrrev_b32 v1, 6, v0
    v_and_b32 v0, 63, v0
    v_readfirstlane_b32 s3, v1
    s_mul_i32 s2, s2, 4
    s_add_u32 s2, s2, s3
    v_lshlrev_b32 v1, 3, v0
    v_lshlrev_b32 v2, 4, v0
    s_waitcnt lgkmcnt(0)
    s_add_u32 s10, s8, 16777216
    s_addc_u32 s11, s9, 0
    s_add_u32 s12, s8, 17825792
    s_addc_u32 s13, s9, 0
    s_lshl_b32 s14, s2, 2
    s_lshl_b32 s15, s2, 10
    s_load_dword s16, s[10:11], s14
    s_load_dwordx16 s[40:55], s[12:13], s15 offset:0
    s_load_dwordx16 s[56:71], s[12:13], s15 offset:64
    s_load_dwordx16 s[72:87], s[12:13], s15 offset:128
    s_mov_b32 s20, s4
    s_and_b32 s21, s5, 0xffff
    s_mov_b32 s22, 20480000
    s_mov_b32 s23, 0x20000
    s_mov_b32 s24, s6
    s_and_b32 s25, s7, 0xffff
    s_mov_b32 s26, 20480000
    s_mov_b32 s27, 0x20000
    s_mov_b32 s28, s8
    s_and_b32 s29, s9, 0xffff
    s_mov_b32 s30, 15360000
    s_mov_b32 s31, 0x20000
    s_add_u32 s32, s8, 16842752
    s_addc_u32 s33, s9, 0
    s_and_b32 s33, s33, 0xffff
    s_mov_b32 s34, 6144
    s_mov_b32 s35, 0x20000
    s_lshl_b32 s17, s2, 11
    buffer_load_dwordx2 v[44:45], v1, s[20:23], s17 offen offset:0
    buffer_load_dwordx2 v[46:47], v1, s[20:23], s17 offen offset:512
    buffer_load_dwordx2 v[48:49], v1, s[20:23], s17 offen offset:1024
    buffer_load_dwordx2 v[50:51], v1, s[20:23], s17 offen offset:1536
    s_waitcnt lgkmcnt(0)
    s_cmp_eq_u32 s16, 0
    s_cbranch_scc0 K2_some
    s_waitcnt vmcnt(0)
    buffer_store_dwordx2 v[44:45], v1, s[24:27], s17 offen offset:0 sc1
    buffer_store_dwordx2 v[46:47], v1, s[24:27], s17 offen offset:512 sc1
    buffer_store_dwordx2 v[48:49], v1, s[24:27], s17 offen offset:1024 sc1
    buffer_store_dwordx2 v[50:51], v1, s[24:27], s17 offen offset:1536 sc1
    s_endpgm
K2_some:
    buffer_load_dwordx4 v[4:7], v2, s[32:35], 0 offen offset:0
    s_movk_i32 s19, 4096
    buffer_load_dwordx4 v[8:11], v2, s[32:35], 0 offen offset:1024
    buffer_load_dwordx4 v[12:15], v2, s[32:35], 0 offen offset:2048
    buffer_load_dwordx4 v[16:19], v2, s[32:35], 0 offen offset:3072
    buffer_load_dwordx4 v[20:23], v2, s[32:35], s19 offen offset:0
    buffer_load_dwordx4 v[24:27], v2, s[32:35], s19 offen offset:1024
    s_waitcnt vmcnt(6)
    v_lshlrev_b32 v28, 16, v44
    v_and_b32 v29, 0xffff0000, v44
    v_lshlrev_b32 v30, 16, v45
    v_and_b32 v31, 0xffff0000, v45
    v_lshlrev_b32 v32, 16, v46
    v_and_b32 v33, 0xffff0000, v46
    v_lshlrev_b32 v34, 16, v47
    v_and_b32 v35, 0xffff0000, v47
    v_lshlrev_b32 v36, 16, v48
    v_and_b32 v37, 0xffff0000, v48
    v_lshlrev_b32 v38, 16, v49
    v_and_b32 v39, 0xffff0000, v49
    v_lshlrev_b32 v40, 16, v50
    v_and_b32 v41, 0xffff0000, v50
    v_lshlrev_b32 v42, 16, v51
    v_and_b32 v43, 0xffff0000, v51
    s_min_u32 s18, s16, 32
K2_round:
    s_cmp_eq_u32 s18, 1
    s_cbranch_scc1 K2_I0
    s_cmp_eq_u32 s18, 2
    s_cbranch_scc1 K2_I1
    s_cmp_eq_u32 s18, 3
    s_cbranch_scc1 K2_I2
    s_cmp_eq_u32 s18, 4
    s_cbranch_scc1 K2_I3
    s_cmp_eq_u32 s18, 5
    s_cbranch_scc1 K2_I4
K2_I5:
    s_mul_i32 s34, s80, 1536
    s_lshl_b32 s35, s80, 11
    buffer_load_dwordx2 v[104:105], v1, s[28:31], s34 offen offset:0
    buffer_load_dwordx2 v[106:107], v1, s[28:31], s34 offen offset:512
    buffer_load_dwordx2 v[108:109], v1, s[28:31], s34 offen offset:1024
    buffer_load_dwordx2 v[110:111], v1, s[20:23], s35 offen offset:512
    buffer_load_dwordx2 v[112:113], v1, s[20:23], s35 offen offset:1024
    buffer_load_dwordx2 v[114:115], v1, s[20:23], s35 offen offset:1536
K2_I4:
    s_mul_i32 s34, s72, 1536
    s_lshl_b32 s35, s72, 11
    buffer_load_dwordx2 v[92:93], v1, s[28:31], s34 offen offset:0
    buffer_load_dwordx2 v[94:95], v1, s[28:31], s34 offen offset:512
    buffer_load_dwordx2 v[96:97], v1, s[28:31], s34 offen offset:1024
    buffer_load_dwordx2 v[98:99], v1, s[20:23], s35 offen offset:512
    buffer_load_dwordx2 v[100:101], v1, s[20:23], s35 offen offset:1024
    buffer_load_dwordx2 v[102:103], v1, s[20:23], s35 offen offset:1536
K2_I3:
    s_mul_i32 s34, s64, 1536
    s_lshl_b32 s35, s64, 11
    buffer_load_dwordx2 v[80:81], v1, s[28:31], s34 offen offset:0
    buffer_load_dwordx2 v[82:83], v1, s[28:31], s34 offen offset:512
    buffer_load_dwordx2 v[84:85], v1, s[28:31], s34 offen offset:1024
    buffer_load_dwordx2 v[86:87], v1, s[20:23], s35 offen offset:512
    buffer_load_dwordx2 v[88:89], v1, s[20:23], s35 offen offset:1024
    buffer_load_dwordx2 v[90:91], v1, s[20:23], s35 offen offset:1536
K2_I2:
    s_mul_i32 s34, s56, 1536
    s_lshl_b32 s35, s56, 11
    buffer_load_dwordx2 v[68:69], v1, s[28:31], s34 offen offset:0
    buffer_load_dwordx2 v[70:71], v1, s[28:31], s34 offen offset:512
    buffer_load_dwordx2 v[72:73], v1, s[28:31], s34 offen offset:1024
    buffer_load_dwordx2 v[74:75], v1, s[20:23], s35 offen offset:512
    buffer_load_dwordx2 v[76:77], v1, s[20:23], s35 offen offset:1024
    buffer_load_dwordx2 v[78:79], v1, s[20:23], s35 offen offset:1536
K2_I1:
    s_mul_i32 s34, s48, 1536
    s_lshl_b32 s35, s48, 11
    buffer_load_dwordx2 v[56:57], v1, s[28:31], s34 offen offset:0
    buffer_load_dwordx2 v[58:59], v1, s[28:31], s34 offen offset:512
    buffer_load_dwordx2 v[60:61], v1, s[28:31], s34 offen offset:1024
    buffer_load_dwordx2 v[62:63], v1, s[20:23], s35 offen offset:512
    buffer_load_dwordx2 v[64:65], v1, s[20:23], s35 offen offset:1024
    buffer_load_dwordx2 v[66:67], v1, s[20:23], s35 offen offset:1536
K2_I0:
    s_mul_i32 s34, s40, 1536
    s_lshl_b32 s35, s40, 11
    buffer_load_dwordx2 v[44:45], v1, s[28:31], s34 offen offset:0
    buffer_load_dwordx2 v[46:47], v1, s[28:31], s34 offen offset:512
    buffer_load_dwordx2 v[48:49], v1, s[28:31], s34 offen offset:1024
    buffer_load_dwordx2 v[50:51], v1, s[20:23], s35 offen offset:512
    buffer_load_dwordx2 v[52:53], v1, s[20:23], s35 offen offset:1024
    buffer_load_dwordx2 v[54:55], v1, s[20:23], s35 offen offset:1536
    s_cmp_eq_u32 s18, 1
    s_cbranch_scc1 K2_B0
    s_cmp_eq_u32 s18, 2
    s_cbranch_scc1 K2_B1
    s_cmp_eq_u32 s18, 3
    s_cbranch_scc1 K2_B2
    s_cmp_eq_u32 s18, 4
    s_cbranch_scc1 K2_B3
    s_cmp_eq_u32 s18, 5
    s_cbranch_scc1 K2_B4
K2_B5:
    s_waitcnt vmcnt(30)
    v_dot2_f32_bf16 v116, v4, s81, 0
    v_dot2_f32_bf16 v117, v5, s81, 0
    v_dot2_f32_bf16 v118, v6, s81, 0
    v_dot2_f32_bf16 v119, v7, s81, 0
    v_dot2_f32_bf16 v116, v8, s82, v116
    v_dot2_f32_bf16 v117, v9, s82, v117
    v_dot2_f32_bf16 v118, v10, s82, v118
    v_dot2_f32_bf16 v119, v11, s82, v119
    v_lshlrev_b32 v120, 16, v104
    v_and_b32 v121, 0xffff0000, v104
    v_lshlrev_b32 v122, 16, v105
    v_and_b32 v123, 0xffff0000, v105
    v_fmac_f32 v28, v116, v120
    v_fmac_f32 v29, v117, v121
    v_fmac_f32 v30, v118, v122
    v_fmac_f32 v31, v119, v123
    v_dot2_f32_bf16 v116, v20, s81, 0
    v_dot2_f32_bf16 v117, v21, s81, 0
    v_dot2_f32_bf16 v118, v22, s81, 0
    v_dot2_f32_bf16 v119, v23, s81, 0
    v_dot2_f32_bf16 v116, v24, s82, v116
    v_dot2_f32_bf16 v117, v25, s82, v117
    v_dot2_f32_bf16 v118, v26, s82, v118
    v_dot2_f32_bf16 v119, v27, s82, v119
    v_lshlrev_b32 v120, 16, v108
    v_and_b32 v121, 0xffff0000, v108
    v_lshlrev_b32 v122, 16, v109
    v_and_b32 v123, 0xffff0000, v109
    v_mul_f32 v116, v116, v120
    v_mul_f32 v117, v117, v121
    v_mul_f32 v118, v118, v122
    v_mul_f32 v119, v119, v123
    v_fmac_f32 v32, s83, v116
    v_fmac_f32 v33, s83, v117
    v_fmac_f32 v34, s83, v118
    v_fmac_f32 v35, s83, v119
    v_fmac_f32 v36, s84, v116
    v_fmac_f32 v37, s84, v117
    v_fmac_f32 v38, s84, v118
    v_fmac_f32 v39, s84, v119
    v_fmac_f32 v40, s85, v116
    v_fmac_f32 v41, s85, v117
    v_fmac_f32 v42, s85, v118
    v_fmac_f32 v43, s85, v119
    v_dot2_f32_bf16 v116, v12, s81, 0
    v_dot2_f32_bf16 v117, v13, s81, 0
    v_dot2_f32_bf16 v118, v14, s81, 0
    v_dot2_f32_bf16 v119, v15, s81, 0
    v_dot2_f32_bf16 v116, v16, s82, v116
    v_dot2_f32_bf16 v117, v17, s82, v117
    v_dot2_f32_bf16 v118, v18, s82, v118
    v_dot2_f32_bf16 v119, v19, s82, v119
    v_lshlrev_b32 v120, 16, v106
    v_and_b32 v121, 0xffff0000, v106
    v_lshlrev_b32 v122, 16, v107
    v_and_b32 v123, 0xffff0000, v107
    v_mul_f32 v116, v116, v120
    v_mul_f32 v117, v117, v121
    v_mul_f32 v118, v118, v122
    v_mul_f32 v119, v119, v123
    v_lshlrev_b32 v120, 16, v110
    v_and_b32 v121, 0xffff0000, v110
    v_lshlrev_b32 v122, 16, v111
    v_and_b32 v123, 0xffff0000, v111
    v_fmac_f32 v32, v116, v120
    v_fmac_f32 v33, v117, v121
    v_fmac_f32 v34, v118, v122
    v_fmac_f32 v35, v119, v123
    v_lshlrev_b32 v120, 16, v112
    v_and_b32 v121, 0xffff0000, v112
    v_lshlrev_b32 v122, 16, v113
    v_and_b32 v123, 0xffff0000, v113
    v_fmac_f32 v36, v116, v120
    v_fmac_f32 v37, v117, v121
    v_fmac_f32 v38, v118, v122
    v_fmac_f32 v39, v119, v123
    v_lshlrev_b32 v120, 16, v114
    v_and_b32 v121, 0xffff0000, v114
    v_lshlrev_b32 v122, 16, v115
    v_and_b32 v123, 0xffff0000, v115
    v_fmac_f32 v40, v116, v120
    v_fmac_f32 v41, v117, v121
    v_fmac_f32 v42, v118, v122
    v_fmac_f32 v43, v119, v123
K2_B4:
    s_waitcnt vmcnt(24)
    v_dot2_f32_bf16 v116, v4, s73, 0
    v_dot2_f32_bf16 v117, v5, s73, 0
    v_dot2_f32_bf16 v118, v6, s73, 0
    v_dot2_f32_bf16 v119, v7, s73, 0
    v_dot2_f32_bf16 v116, v8, s74, v116
    v_dot2_f32_bf16 v117, v9, s74, v117
    v_dot2_f32_bf16 v118, v10, s74, v118
    v_dot2_f32_bf16 v119, v11, s74, v119
    v_lshlrev_b32 v120, 16, v92
    v_and_b32 v121, 0xffff0000, v92
    v_lshlrev_b32 v122, 16, v93
    v_and_b32 v123, 0xffff0000, v93
    v_fmac_f32 v28, v116, v120
    v_fmac_f32 v29, v117, v121
    v_fmac_f32 v30, v118, v122
    v_fmac_f32 v31, v119, v123
    v_dot2_f32_bf16 v116, v20, s73, 0
    v_dot2_f32_bf16 v117, v21, s73, 0
    v_dot2_f32_bf16 v118, v22, s73, 0
    v_dot2_f32_bf16 v119, v23, s73, 0
    v_dot2_f32_bf16 v116, v24, s74, v116
    v_dot2_f32_bf16 v117, v25, s74, v117
    v_dot2_f32_bf16 v118, v26, s74, v118
    v_dot2_f32_bf16 v119, v27, s74, v119
    v_lshlrev_b32 v120, 16, v96
    v_and_b32 v121, 0xffff0000, v96
    v_lshlrev_b32 v122, 16, v97
    v_and_b32 v123, 0xffff0000, v97
    v_mul_f32 v116, v116, v120
    v_mul_f32 v117, v117, v121
    v_mul_f32 v118, v118, v122
    v_mul_f32 v119, v119, v123
    v_fmac_f32 v32, s75, v116
    v_fmac_f32 v33, s75, v117
    v_fmac_f32 v34, s75, v118
    v_fmac_f32 v35, s75, v119
    v_fmac_f32 v36, s76, v116
    v_fmac_f32 v37, s76, v117
    v_fmac_f32 v38, s76, v118
    v_fmac_f32 v39, s76, v119
    v_fmac_f32 v40, s77, v116
    v_fmac_f32 v41, s77, v117
    v_fmac_f32 v42, s77, v118
    v_fmac_f32 v43, s77, v119
    v_dot2_f32_bf16 v116, v12, s73, 0
    v_dot2_f32_bf16 v117, v13, s73, 0
    v_dot2_f32_bf16 v118, v14, s73, 0
    v_dot2_f32_bf16 v119, v15, s73, 0
    v_dot2_f32_bf16 v116, v16, s74, v116
    v_dot2_f32_bf16 v117, v17, s74, v117
    v_dot2_f32_bf16 v118, v18, s74, v118
    v_dot2_f32_bf16 v119, v19, s74, v119
    v_lshlrev_b32 v120, 16, v94
    v_and_b32 v121, 0xffff0000, v94
    v_lshlrev_b32 v122, 16, v95
    v_and_b32 v123, 0xffff0000, v95
    v_mul_f32 v116, v116, v120
    v_mul_f32 v117, v117, v121
    v_mul_f32 v118, v118, v122
    v_mul_f32 v119, v119, v123
    v_lshlrev_b32 v120, 16, v98
    v_and_b32 v121, 0xffff0000, v98
    v_lshlrev_b32 v122, 16, v99
    v_and_b32 v123, 0xffff0000, v99
    v_fmac_f32 v32, v116, v120
    v_fmac_f32 v33, v117, v121
    v_fmac_f32 v34, v118, v122
    v_fmac_f32 v35, v119, v123
    v_lshlrev_b32 v120, 16, v100
    v_and_b32 v121, 0xffff0000, v100
    v_lshlrev_b32 v122, 16, v101
    v_and_b32 v123, 0xffff0000, v101
    v_fmac_f32 v36, v116, v120
    v_fmac_f32 v37, v117, v121
    v_fmac_f32 v38, v118, v122
    v_fmac_f32 v39, v119, v123
    v_lshlrev_b32 v120, 16, v102
    v_and_b32 v121, 0xffff0000, v102
    v_lshlrev_b32 v122, 16, v103
    v_and_b32 v123, 0xffff0000, v103
    v_fmac_f32 v40, v116, v120
    v_fmac_f32 v41, v117, v121
    v_fmac_f32 v42, v118, v122
    v_fmac_f32 v43, v119, v123
K2_B3:
    s_waitcnt vmcnt(18)
    v_dot2_f32_bf16 v116, v4, s65, 0
    v_dot2_f32_bf16 v117, v5, s65, 0
    v_dot2_f32_bf16 v118, v6, s65, 0
    v_dot2_f32_bf16 v119, v7, s65, 0
    v_dot2_f32_bf16 v116, v8, s66, v116
    v_dot2_f32_bf16 v117, v9, s66, v117
    v_dot2_f32_bf16 v118, v10, s66, v118
    v_dot2_f32_bf16 v119, v11, s66, v119
    v_lshlrev_b32 v120, 16, v80
    v_and_b32 v121, 0xffff0000, v80
    v_lshlrev_b32 v122, 16, v81
    v_and_b32 v123, 0xffff0000, v81
    v_fmac_f32 v28, v116, v120
    v_fmac_f32 v29, v117, v121
    v_fmac_f32 v30, v118, v122
    v_fmac_f32 v31, v119, v123
    v_dot2_f32_bf16 v116, v20, s65, 0
    v_dot2_f32_bf16 v117, v21, s65, 0
    v_dot2_f32_bf16 v118, v22, s65, 0
    v_dot2_f32_bf16 v119, v23, s65, 0
    v_dot2_f32_bf16 v116, v24, s66, v116
    v_dot2_f32_bf16 v117, v25, s66, v117
    v_dot2_f32_bf16 v118, v26, s66, v118
    v_dot2_f32_bf16 v119, v27, s66, v119
    v_lshlrev_b32 v120, 16, v84
    v_and_b32 v121, 0xffff0000, v84
    v_lshlrev_b32 v122, 16, v85
    v_and_b32 v123, 0xffff0000, v85
    v_mul_f32 v116, v116, v120
    v_mul_f32 v117, v117, v121
    v_mul_f32 v118, v118, v122
    v_mul_f32 v119, v119, v123
    v_fmac_f32 v32, s67, v116
    v_fmac_f32 v33, s67, v117
    v_fmac_f32 v34, s67, v118
    v_fmac_f32 v35, s67, v119
    v_fmac_f32 v36, s68, v116
    v_fmac_f32 v37, s68, v117
    v_fmac_f32 v38, s68, v118
    v_fmac_f32 v39, s68, v119
    v_fmac_f32 v40, s69, v116
    v_fmac_f32 v41, s69, v117
    v_fmac_f32 v42, s69, v118
    v_fmac_f32 v43, s69, v119
    v_dot2_f32_bf16 v116, v12, s65, 0
    v_dot2_f32_bf16 v117, v13, s65, 0
    v_dot2_f32_bf16 v118, v14, s65, 0
    v_dot2_f32_bf16 v119, v15, s65, 0
    v_dot2_f32_bf16 v116, v16, s66, v116
    v_dot2_f32_bf16 v117, v17, s66, v117
    v_dot2_f32_bf16 v118, v18, s66, v118
    v_dot2_f32_bf16 v119, v19, s66, v119
    v_lshlrev_b32 v120, 16, v82
    v_and_b32 v121, 0xffff0000, v82
    v_lshlrev_b32 v122, 16, v83
    v_and_b32 v123, 0xffff0000, v83
    v_mul_f32 v116, v116, v120
    v_mul_f32 v117, v117, v121
    v_mul_f32 v118, v118, v122
    v_mul_f32 v119, v119, v123
    v_lshlrev_b32 v120, 16, v86
    v_and_b32 v121, 0xffff0000, v86
    v_lshlrev_b32 v122, 16, v87
    v_and_b32 v123, 0xffff0000, v87
    v_fmac_f32 v32, v116, v120
    v_fmac_f32 v33, v117, v121
    v_fmac_f32 v34, v118, v122
    v_fmac_f32 v35, v119, v123
    v_lshlrev_b32 v120, 16, v88
    v_and_b32 v121, 0xffff0000, v88
    v_lshlrev_b32 v122, 16, v89
    v_and_b32 v123, 0xffff0000, v89
    v_fmac_f32 v36, v116, v120
    v_fmac_f32 v37, v117, v121
    v_fmac_f32 v38, v118, v122
    v_fmac_f32 v39, v119, v123
    v_lshlrev_b32 v120, 16, v90
    v_and_b32 v121, 0xffff0000, v90
    v_lshlrev_b32 v122, 16, v91
    v_and_b32 v123, 0xffff0000, v91
    v_fmac_f32 v40, v116, v120
    v_fmac_f32 v41, v117, v121
    v_fmac_f32 v42, v118, v122
    v_fmac_f32 v43, v119, v123
K2_B2:
    s_waitcnt vmcnt(12)
    v_dot2_f32_bf16 v116, v4, s57, 0
    v_dot2_f32_bf16 v117, v5, s57, 0
    v_dot2_f32_bf16 v118, v6, s57, 0
    v_dot2_f32_bf16 v119, v7, s57, 0
    v_dot2_f32_bf16 v116, v8, s58, v116
    v_dot2_f32_bf16 v117, v9, s58, v117
    v_dot2_f32_bf16 v118, v10, s58, v118
    v_dot2_f32_bf16 v119, v11, s58, v119
    v_lshlrev_b32 v120, 16, v68
    v_and_b32 v121, 0xffff0000, v68
    v_lshlrev_b32 v122, 16, v69
    v_and_b32 v123, 0xffff0000, v69
    v_fmac_f32 v28, v116, v120
    v_fmac_f32 v29, v117, v121
    v_fmac_f32 v30, v118, v122
    v_fmac_f32 v31, v119, v123
    v_dot2_f32_bf16 v116, v20, s57, 0
    v_dot2_f32_bf16 v117, v21, s57, 0
    v_dot2_f32_bf16 v118, v22, s57, 0
    v_dot2_f32_bf16 v119, v23, s57, 0
    v_dot2_f32_bf16 v116, v24, s58, v116
    v_dot2_f32_bf16 v117, v25, s58, v117
    v_dot2_f32_bf16 v118, v26, s58, v118
    v_dot2_f32_bf16 v119, v27, s58, v119
    v_lshlrev_b32 v120, 16, v72
    v_and_b32 v121, 0xffff0000, v72
    v_lshlrev_b32 v122, 16, v73
    v_and_b32 v123, 0xffff0000, v73
    v_mul_f32 v116, v116, v120
    v_mul_f32 v117, v117, v121
    v_mul_f32 v118, v118, v122
    v_mul_f32 v119, v119, v123
    v_fmac_f32 v32, s59, v116
    v_fmac_f32 v33, s59, v117
    v_fmac_f32 v34, s59, v118
    v_fmac_f32 v35, s59, v119
    v_fmac_f32 v36, s60, v116
    v_fmac_f32 v37, s60, v117
    v_fmac_f32 v38, s60, v118
    v_fmac_f32 v39, s60, v119
    v_fmac_f32 v40, s61, v116
    v_fmac_f32 v41, s61, v117
    v_fmac_f32 v42, s61, v118
    v_fmac_f32 v43, s61, v119
    v_dot2_f32_bf16 v116, v12, s57, 0
    v_dot2_f32_bf16 v117, v13, s57, 0
    v_dot2_f32_bf16 v118, v14, s57, 0
    v_dot2_f32_bf16 v119, v15, s57, 0
    v_dot2_f32_bf16 v116, v16, s58, v116
    v_dot2_f32_bf16 v117, v17, s58, v117
    v_dot2_f32_bf16 v118, v18, s58, v118
    v_dot2_f32_bf16 v119, v19, s58, v119
    v_lshlrev_b32 v120, 16, v70
    v_and_b32 v121, 0xffff0000, v70
    v_lshlrev_b32 v122, 16, v71
    v_and_b32 v123, 0xffff0000, v71
    v_mul_f32 v116, v116, v120
    v_mul_f32 v117, v117, v121
    v_mul_f32 v118, v118, v122
    v_mul_f32 v119, v119, v123
    v_lshlrev_b32 v120, 16, v74
    v_and_b32 v121, 0xffff0000, v74
    v_lshlrev_b32 v122, 16, v75
    v_and_b32 v123, 0xffff0000, v75
    v_fmac_f32 v32, v116, v120
    v_fmac_f32 v33, v117, v121
    v_fmac_f32 v34, v118, v122
    v_fmac_f32 v35, v119, v123
    v_lshlrev_b32 v120, 16, v76
    v_and_b32 v121, 0xffff0000, v76
    v_lshlrev_b32 v122, 16, v77
    v_and_b32 v123, 0xffff0000, v77
    v_fmac_f32 v36, v116, v120
    v_fmac_f32 v37, v117, v121
    v_fmac_f32 v38, v118, v122
    v_fmac_f32 v39, v119, v123
    v_lshlrev_b32 v120, 16, v78
    v_and_b32 v121, 0xffff0000, v78
    v_lshlrev_b32 v122, 16, v79
    v_and_b32 v123, 0xffff0000, v79
    v_fmac_f32 v40, v116, v120
    v_fmac_f32 v41, v117, v121
    v_fmac_f32 v42, v118, v122
    v_fmac_f32 v43, v119, v123
K2_B1:
    s_waitcnt vmcnt(6)
    v_dot2_f32_bf16 v116, v4, s49, 0
    v_dot2_f32_bf16 v117, v5, s49, 0
    v_dot2_f32_bf16 v118, v6, s49, 0
    v_dot2_f32_bf16 v119, v7, s49, 0
    v_dot2_f32_bf16 v116, v8, s50, v116
    v_dot2_f32_bf16 v117, v9, s50, v117
    v_dot2_f32_bf16 v118, v10, s50, v118
    v_dot2_f32_bf16 v119, v11, s50, v119
    v_lshlrev_b32 v120, 16, v56
    v_and_b32 v121, 0xffff0000, v56
    v_lshlrev_b32 v122, 16, v57
    v_and_b32 v123, 0xffff0000, v57
    v_fmac_f32 v28, v116, v120
    v_fmac_f32 v29, v117, v121
    v_fmac_f32 v30, v118, v122
    v_fmac_f32 v31, v119, v123
    v_dot2_f32_bf16 v116, v20, s49, 0
    v_dot2_f32_bf16 v117, v21, s49, 0
    v_dot2_f32_bf16 v118, v22, s49, 0
    v_dot2_f32_bf16 v119, v23, s49, 0
    v_dot2_f32_bf16 v116, v24, s50, v116
    v_dot2_f32_bf16 v117, v25, s50, v117
    v_dot2_f32_bf16 v118, v26, s50, v118
    v_dot2_f32_bf16 v119, v27, s50, v119
    v_lshlrev_b32 v120, 16, v60
    v_and_b32 v121, 0xffff0000, v60
    v_lshlrev_b32 v122, 16, v61
    v_and_b32 v123, 0xffff0000, v61
    v_mul_f32 v116, v116, v120
    v_mul_f32 v117, v117, v121
    v_mul_f32 v118, v118, v122
    v_mul_f32 v119, v119, v123
    v_fmac_f32 v32, s51, v116
    v_fmac_f32 v33, s51, v117
    v_fmac_f32 v34, s51, v118
    v_fmac_f32 v35, s51, v119
    v_fmac_f32 v36, s52, v116
    v_fmac_f32 v37, s52, v117
    v_fmac_f32 v38, s52, v118
    v_fmac_f32 v39, s52, v119
    v_fmac_f32 v40, s53, v116
    v_fmac_f32 v41, s53, v117
    v_fmac_f32 v42, s53, v118
    v_fmac_f32 v43, s53, v119
    v_dot2_f32_bf16 v116, v12, s49, 0
    v_dot2_f32_bf16 v117, v13, s49, 0
    v_dot2_f32_bf16 v118, v14, s49, 0
    v_dot2_f32_bf16 v119, v15, s49, 0
    v_dot2_f32_bf16 v116, v16, s50, v116
    v_dot2_f32_bf16 v117, v17, s50, v117
    v_dot2_f32_bf16 v118, v18, s50, v118
    v_dot2_f32_bf16 v119, v19, s50, v119
    v_lshlrev_b32 v120, 16, v58
    v_and_b32 v121, 0xffff0000, v58
    v_lshlrev_b32 v122, 16, v59
    v_and_b32 v123, 0xffff0000, v59
    v_mul_f32 v116, v116, v120
    v_mul_f32 v117, v117, v121
    v_mul_f32 v118, v118, v122
    v_mul_f32 v119, v119, v123
    v_lshlrev_b32 v120, 16, v62
    v_and_b32 v121, 0xffff0000, v62
    v_lshlrev_b32 v122, 16, v63
    v_and_b32 v123, 0xffff0000, v63
    v_fmac_f32 v32, v116, v120
    v_fmac_f32 v33, v117, v121
    v_fmac_f32 v34, v118, v122
    v_fmac_f32 v35, v119, v123
    v_lshlrev_b32 v120, 16, v64
    v_and_b32 v121, 0xffff0000, v64
    v_lshlrev_b32 v122, 16, v65
    v_and_b32 v123, 0xffff0000, v65
    v_fmac_f32 v36, v116, v120
    v_fmac_f32 v37, v117, v121
    v_fmac_f32 v38, v118, v122
    v_fmac_f32 v39, v119, v123
    v_lshlrev_b32 v120, 16, v66
    v_and_b32 v121, 0xffff0000, v66
    v_lshlrev_b32 v122, 16, v67
    v_and_b32 v123, 0xffff0000, v67
    v_fmac_f32 v40, v116, v120
    v_fmac_f32 v41, v117, v121
    v_fmac_f32 v42, v118, v122
    v_fmac_f32 v43, v119, v123
K2_B0:
    s_waitcnt vmcnt(0)
    v_dot2_f32_bf16 v116, v4, s41, 0
    v_dot2_f32_bf16 v117, v5, s41, 0
    v_dot2_f32_bf16 v118, v6, s41, 0
    v_dot2_f32_bf16 v119, v7, s41, 0
    v_dot2_f32_bf16 v116, v8, s42, v116
    v_dot2_f32_bf16 v117, v9, s42, v117
    v_dot2_f32_bf16 v118, v10, s42, v118
    v_dot2_f32_bf16 v119, v11, s42, v119
    v_lshlrev_b32 v120, 16, v44
    v_and_b32 v121, 0xffff0000, v44
    v_lshlrev_b32 v122, 16, v45
    v_and_b32 v123, 0xffff0000, v45
    v_fmac_f32 v28, v116, v120
    v_fmac_f32 v29, v117, v121
    v_fmac_f32 v30, v118, v122
    v_fmac_f32 v31, v119, v123
    v_dot2_f32_bf16 v116, v20, s41, 0
    v_dot2_f32_bf16 v117, v21, s41, 0
    v_dot2_f32_bf16 v118, v22, s41, 0
    v_dot2_f32_bf16 v119, v23, s41, 0
    v_dot2_f32_bf16 v116, v24, s42, v116
    v_dot2_f32_bf16 v117, v25, s42, v117
    v_dot2_f32_bf16 v118, v26, s42, v118
    v_dot2_f32_bf16 v119, v27, s42, v119
    v_lshlrev_b32 v120, 16, v48
    v_and_b32 v121, 0xffff0000, v48
    v_lshlrev_b32 v122, 16, v49
    v_and_b32 v123, 0xffff0000, v49
    v_mul_f32 v116, v116, v120
    v_mul_f32 v117, v117, v121
    v_mul_f32 v118, v118, v122
    v_mul_f32 v119, v119, v123
    v_fmac_f32 v32, s43, v116
    v_fmac_f32 v33, s43, v117
    v_fmac_f32 v34, s43, v118
    v_fmac_f32 v35, s43, v119
    v_fmac_f32 v36, s44, v116
    v_fmac_f32 v37, s44, v117
    v_fmac_f32 v38, s44, v118
    v_fmac_f32 v39, s44, v119
    v_fmac_f32 v40, s45, v116
    v_fmac_f32 v41, s45, v117
    v_fmac_f32 v42, s45, v118
    v_fmac_f32 v43, s45, v119
    v_dot2_f32_bf16 v116, v12, s41, 0
    v_dot2_f32_bf16 v117, v13, s41, 0
    v_dot2_f32_bf16 v118, v14, s41, 0
    v_dot2_f32_bf16 v119, v15, s41, 0
    v_dot2_f32_bf16 v116, v16, s42, v116
    v_dot2_f32_bf16 v117, v17, s42, v117
    v_dot2_f32_bf16 v118, v18, s42, v118
    v_dot2_f32_bf16 v119, v19, s42, v119
    v_lshlrev_b32 v120, 16, v46
    v_and_b32 v121, 0xffff0000, v46
    v_lshlrev_b32 v122, 16, v47
    v_and_b32 v123, 0xffff0000, v47
    v_mul_f32 v116, v116, v120
    v_mul_f32 v117, v117, v121
    v_mul_f32 v118, v118, v122
    v_mul_f32 v119, v119, v123
    v_lshlrev_b32 v120, 16, v50
    v_and_b32 v121, 0xffff0000, v50
    v_lshlrev_b32 v122, 16, v51
    v_and_b32 v123, 0xffff0000, v51
    v_fmac_f32 v32, v116, v120
    v_fmac_f32 v33, v117, v121
    v_fmac_f32 v34, v118, v122
    v_fmac_f32 v35, v119, v123
    v_lshlrev_b32 v120, 16, v52
    v_and_b32 v121, 0xffff0000, v52
    v_lshlrev_b32 v122, 16, v53
    v_and_b32 v123, 0xffff0000, v53
    v_fmac_f32 v36, v116, v120
    v_fmac_f32 v37, v117, v121
    v_fmac_f32 v38, v118, v122
    v_fmac_f32 v39, v119, v123
    v_lshlrev_b32 v120, 16, v54
    v_and_b32 v121, 0xffff0000, v54
    v_lshlrev_b32 v122, 16, v55
    v_and_b32 v123, 0xffff0000, v55
    v_fmac_f32 v40, v116, v120
    v_fmac_f32 v41, v117, v121
    v_fmac_f32 v42, v118, v122
    v_fmac_f32 v43, v119, v123
    s_cmp_le_u32 s18, 6
    s_cbranch_scc1 K2_bdone
    s_sub_u32 s18, s18, 6
    s_add_u32 s15, s15, 192
    s_load_dwordx16 s[40:55], s[12:13], s15 offset:0
    s_load_dwordx16 s[56:71], s[12:13], s15 offset:64
    s_load_dwordx16 s[72:87], s[12:13], s15 offset:128
    s_waitcnt lgkmcnt(0)
    s_branch K2_round
K2_bdone:
    s_cmp_le_u32 s16, 32
    s_cbranch_scc1 K2_fin
    s_load_dword s18, s[10:11], 40000
    s_add_u32 s12, s8, 33554432
    s_addc_u32 s13, s9, 0
    s_mov_b32 s15, 0
    s_waitcnt lgkmcnt(0)
    s_lshl_b32 s18, s18, 5
K2_ovf:
    s_cmp_ge_u32 s15, s18
    s_cbranch_scc1 K2_fin
    s_load_dwordx8 s[40:47], s[12:13], s15
    s_add_u32 s15, s15, 32
    s_waitcnt lgkmcnt(0)
    s_cmp_eq_u32 s46, s2
    s_cbranch_scc0 K2_ovf
    s_mul_i32 s34, s40, 1536
    s_lshl_b32 s35, s40, 11
    buffer_load_dwordx2 v[44:45], v1, s[28:31], s34 offen offset:0
    buffer_load_dwordx2 v[46:47], v1, s[28:31], s34 offen offset:512
    buffer_load_dwordx2 v[48:49], v1, s[28:31], s34 offen offset:1024
    buffer_load_dwordx2 v[50:51], v1, s[20:23], s35 offen offset:512
    buffer_load_dwordx2 v[52:53], v1, s[20:23], s35 offen offset:1024
    buffer_load_dwordx2 v[54:55], v1, s[20:23], s35 offen offset:1536
    s_waitcnt vmcnt(0)
    v_dot2_f32_bf16 v116, v4, s41, 0
    v_dot2_f32_bf16 v117, v5, s41, 0
    v_dot2_f32_bf16 v118, v6, s41, 0
    v_dot2_f32_bf16 v119, v7, s41, 0
    v_dot2_f32_bf16 v116, v8, s42, v116
    v_dot2_f32_bf16 v117, v9, s42, v117
    v_dot2_f32_bf16 v118, v10, s42, v118
    v_dot2_f32_bf16 v119, v11, s42, v119
    v_lshlrev_b32 v120, 16, v44
    v_and_b32 v121, 0xffff0000, v44
    v_lshlrev_b32 v122, 16, v45
    v_and_b32 v123, 0xffff0000, v45
    v_fmac_f32 v28, v116, v120
    v_fmac_f32 v29, v117, v121
    v_fmac_f32 v30, v118, v122
    v_fmac_f32 v31, v119, v123
    v_dot2_f32_bf16 v116, v20, s41, 0
    v_dot2_f32_bf16 v117, v21, s41, 0
    v_dot2_f32_bf16 v118, v22, s41, 0
    v_dot2_f32_bf16 v119, v23, s41, 0
    v_dot2_f32_bf16 v116, v24, s42, v116
    v_dot2_f32_bf16 v117, v25, s42, v117
    v_dot2_f32_bf16 v118, v26, s42, v118
    v_dot2_f32_bf16 v119, v27, s42, v119
    v_lshlrev_b32 v120, 16, v48
    v_and_b32 v121, 0xffff0000, v48
    v_lshlrev_b32 v122, 16, v49
    v_and_b32 v123, 0xffff0000, v49
    v_mul_f32 v116, v116, v120
    v_mul_f32 v117, v117, v121
    v_mul_f32 v118, v118, v122
    v_mul_f32 v119, v119, v123
    v_fmac_f32 v32, s43, v116
    v_fmac_f32 v33, s43, v117
    v_fmac_f32 v34, s43, v118
    v_fmac_f32 v35, s43, v119
    v_fmac_f32 v36, s44, v116
    v_fmac_f32 v37, s44, v117
    v_fmac_f32 v38, s44, v118
    v_fmac_f32 v39, s44, v119
    v_fmac_f32 v40, s45, v116
    v_fmac_f32 v41, s45, v117
    v_fmac_f32 v42, s45, v118
    v_fmac_f32 v43, s45, v119
    v_dot2_f32_bf16 v116, v12, s41, 0
    v_dot2_f32_bf16 v117, v13, s41, 0
    v_dot2_f32_bf16 v118, v14, s41, 0
    v_dot2_f32_bf16 v119, v15, s41, 0
    v_dot2_f32_bf16 v116, v16, s42, v116
    v_dot2_f32_bf16 v117, v17, s42, v117
    v_dot2_f32_bf16 v118, v18, s42, v118
    v_dot2_f32_bf16 v119, v19, s42, v119
    v_lshlrev_b32 v120, 16, v46
    v_and_b32 v121, 0xffff0000, v46
    v_lshlrev_b32 v122, 16, v47
    v_and_b32 v123, 0xffff0000, v47
    v_mul_f32 v116, v116, v120
    v_mul_f32 v117, v117, v121
    v_mul_f32 v118, v118, v122
    v_mul_f32 v119, v119, v123
    v_lshlrev_b32 v120, 16, v50
    v_and_b32 v121, 0xffff0000, v50
    v_lshlrev_b32 v122, 16, v51
    v_and_b32 v123, 0xffff0000, v51
    v_fmac_f32 v32, v116, v120
    v_fmac_f32 v33, v117, v121
    v_fmac_f32 v34, v118, v122
    v_fmac_f32 v35, v119, v123
    v_lshlrev_b32 v120, 16, v52
    v_and_b32 v121, 0xffff0000, v52
    v_lshlrev_b32 v122, 16, v53
    v_and_b32 v123, 0xffff0000, v53
    v_fmac_f32 v36, v116, v120
    v_fmac_f32 v37, v117, v121
    v_fmac_f32 v38, v118, v122
    v_fmac_f32 v39, v119, v123
    v_lshlrev_b32 v120, 16, v54
    v_and_b32 v121, 0xffff0000, v54
    v_lshlrev_b32 v122, 16, v55
    v_and_b32 v123, 0xffff0000, v55
    v_fmac_f32 v40, v116, v120
    v_fmac_f32 v41, v117, v121
    v_fmac_f32 v42, v118, v122
    v_fmac_f32 v43, v119, v123
    s_branch K2_ovf
K2_fin:
    v_cvt_pk_bf16_f32 v116, v28, v29
    v_cvt_pk_bf16_f32 v117, v30, v31
    buffer_store_dwordx2 v[116:117], v1, s[24:27], s17 offen offset:0 sc1
    v_cvt_pk_bf16_f32 v118, v32, v33
    v_cvt_pk_bf16_f32 v119, v34, v35
    buffer_store_dwordx2 v[118:119], v1, s[24:27], s17 offen offset:512 sc1
    s_nop 1
    v_cvt_pk_bf16_f32 v116, v36, v37
    v_cvt_pk_bf16_f32 v117, v38, v39
    buffer_store_dwordx2 v[116:117], v1, s[24:27], s17 offen offset:1024 sc1
    v_cvt_pk_bf16_f32 v118, v40, v41
    v_cvt_pk_bf16_f32 v119, v42, v43
    buffer_store_dwordx2 v[118:119], v1, s[24:27], s17 offen offset:1536 sc1
K2_end:
    s_endpgm
.section .rodata,"a"
.p2align 6
.amdhsa_kernel painn_prep_kernel
  .amdhsa_next_free_vgpr 256
  .amdhsa_next_free_sgpr 102
  .amdhsa_accum_offset 256
  .amdhsa_group_segment_fixed_size 0
  .amdhsa_kernarg_size 88
  .amdhsa_user_sgpr_count 2
  .amdhsa_user_sgpr_kernarg_segment_ptr 1
  .amdhsa_system_sgpr_workgroup_id_x 1
.end_amdhsa_kernel
.p2align 6
.amdhsa_kernel gather_scatter__molecular_angular_painn__graph_kernel
  .amdhsa_next_free_vgpr 124
  .amdhsa_next_free_sgpr 88
  .amdhsa_accum_offset 124
  .amdhsa_group_segment_fixed_size 0
  .amdhsa_kernarg_size 88
  .amdhsa_user_sgpr_count 2
  .amdhsa_user_sgpr_kernarg_segment_ptr 1
  .amdhsa_system_sgpr_workgroup_id_x 1
.end_amdhsa_kernel
```
